```python
import torch

def _softmax(x, axis=-1):
    return torch.softmax(x, dim=axis)
def _gelu(x):
    return torch.nn.functional.gelu(x, approximate="tanh")
def _silu(x):
    return torch.nn.functional.silu(x)
def _sigmoid(x):
    return torch.sigmoid(x)
def _layernorm(x, axis=-1, eps=1e-5):
    m = x.mean(dim=axis, keepdim=True)
    v = x.var(dim=axis, keepdim=True, unbiased=False)
    return (x - m) / torch.sqrt(v + eps)
def _scatter_add(tgt, idx, src, axis=0):
    return tgt.clone().index_add_(axis, idx, src)
def _segment_sum(src, seg, n):
    out = torch.zeros((n,) + src.shape[1:], dtype=src.dtype)
    return out.index_add_(0, seg, src)
def _pad(x, pw):
    flat = tuple(v for pair in reversed(pw) for v in pair)
    return torch.nn.functional.pad(x, flat)

kernel_name = 'recurrent_scan__mha_block_cached__swiglu_ffn__decode'

def setup_inputs():

    _w = (lambda a: (lambda t: t.to(torch.bfloat16) if t.is_floating_point() else t)(torch.as_tensor(a)))
    def _A_setup():
        B, Sq, D = 1, 1, 640
        H, Sk, Dh = 32, 4096, 192
        return {
            "x": _w((lambda *s: torch.randn(*s, dtype=torch.bfloat16) * 0.05)(B, Sq, D)),
            "k_cache": _w((lambda *s: torch.randn(*s, dtype=torch.bfloat16) * 1.6)(B, H, Sk, Dh)),
            "v_cache": _w((lambda *s: torch.randn(*s, dtype=torch.bfloat16) * 0.2)(B, H, Sk, Dh)),
            "wq": _w((lambda *s: torch.randn(*s, dtype=torch.bfloat16) * 1.6)(D, H * Dh) * (D ** -0.5)),
            "wo": _w((lambda *s: torch.randn(*s, dtype=torch.bfloat16) * 0.2)(H * Dh, D) * ((H * Dh) ** -0.5)),
        }
    _A_in = _A_setup()

    def _B_setup():
        B, S, D, F = 1, 1, 640, 1536
        return {
            "x": _w((lambda *s: torch.randn(*s, dtype=torch.bfloat16) * 0.05)(B, S, D)),
            "w_gate": _w((lambda *s: torch.randn(*s, dtype=torch.bfloat16) * 0.1)(D, F)),
            "w_up": _w((lambda *s: torch.randn(*s, dtype=torch.bfloat16) * 0.1)(D, F)),
            "w_down": _w((lambda *s: torch.randn(*s, dtype=torch.bfloat16) * 0.1)(F, D)),
        }
    _B_in = _B_setup()

    return {
        "A_x": _A_in["x"],
        "A_k_cache": _A_in["k_cache"],
        "A_v_cache": _A_in["v_cache"],
        "A_wq": _A_in["wq"],
        "A_wo": _A_in["wo"],
        "B_x": _B_in["x"],
        "B_w_gate": _B_in["w_gate"],
        "B_w_up": _B_in["w_up"],
        "B_w_down": _B_in["w_down"],
    }

def reference(A_x, A_k_cache, A_v_cache, A_wq, A_wo, B_x, B_w_gate, B_w_up, B_w_down):
    def _A_ref(x, k_cache, v_cache, wq, wo):
        B, Sq, D = x.shape
        H, Dh = 32, 192
        q = (lambda x, *d: x.permute(*d))((x @ wq).reshape(B, Sq, H, Dh), 0, 2, 1, 3)
        scores = torch.einsum("bhqd,bhkd->bhqk", q, k_cache) * (Dh ** -0.5)
        p = _softmax(scores, axis=-1)
        o = torch.einsum("bhqk,bhkd->bhqd", p, v_cache)
        return (lambda x, *d: x.permute(*d))(o, 0, 2, 1, 3).reshape(B, Sq, H * Dh) @ wo

    def _B_ref(x, w_gate, w_up, w_down):
        g = _silu(x @ w_gate)
        u = x @ w_up
        return (g * u) @ w_down

    x = A_x
    xn = _layernorm(x, axis=-1)
    s = _A_ref(xn, A_k_cache, A_v_cache, A_wq, A_wo)
    g = _silu(_B_ref(xn, B_w_gate, B_w_up, B_w_down))
    return x + s * g
```

```asm
; @launch grid=(256,1,1) block=(512,1,1) lds=33408
.amdgcn_target "amdgcn-amd-amdhsa--gfx950"
.text
.globl recurrent_scan__mha_block_cached__swiglu_ffn__decode_kernel
.p2align 8
.type recurrent_scan__mha_block_cached__swiglu_ffn__decode_kernel,@function
recurrent_scan__mha_block_cached__swiglu_ffn__decode_kernel:
    s_load_dwordx16 s[4:19], s[0:1], 0
    s_load_dwordx8 s[20:27], s[0:1], 64
    s_cmp_ge_u32 s2, 256
    s_cbranch_scc1 L_end
    v_lshrrev_b32 v32, 6, v0
    v_and_b32 v1, 63, v0
    v_readfirstlane_b32 s3, v32
    v_lshrrev_b32 v3, 3, v1
    v_and_b32 v4, 7, v1
    v_mul_u32_u24 v2, 384, v3
    v_lshl_add_u32 v2, v4, 4, v2
    s_lshl_b32 s32, s2, 3
    s_add_u32 s32, s32, s3
    s_mul_i32 s32, s32, 24576
    s_cmp_ge_u32 s3, 4
    s_waitcnt lgkmcnt(0)
    s_cbranch_scc1 L_pro_w
    s_add_u32 s6, s6, s32
    s_addc_u32 s7, s7, 0
    s_setprio 2
    global_load_dwordx4 v[48:51], v2, s[6:7] offset:0 nt
    global_load_dwordx4 v[52:55], v2, s[6:7] offset:128 nt
    global_load_dwordx4 v[56:59], v2, s[6:7] offset:256 nt
    global_load_dwordx4 v[60:63], v2, s[6:7] offset:3072 nt
    global_load_dwordx4 v[64:67], v2, s[6:7] offset:3200 nt
    global_load_dwordx4 v[68:71], v2, s[6:7] offset:3328 nt
    s_add_u32 s8, s8, s32
    s_addc_u32 s9, s9, 0
    s_branch L_pro_j
L_pro_w:
    s_setprio 3
    s_add_u32 s6, s6, s32
    s_addc_u32 s7, s7, 0
    s_add_u32 s8, s8, s32
    s_addc_u32 s9, s9, 0
L_pro_j:
    s_lshr_b32 s30, s2, 3
    s_and_b32 s31, s2, 7
    s_and_b32 s33, s2, 7
    s_lshr_b32 s34, s2, 3
    s_lshr_b32 s35, s33, 1
    s_mul_i32 s32, s35, 60
    s_and_b32 s33, s33, 1
    s_lshl_b32 s15, s33, 5
    s_add_u32 s32, s32, s15
    s_add_u32 s32, s32, s34
    s_lshl_b32 s35, s35, 2
    s_add_u32 s35, s35, s34
    s_add_u32 s35, s35, 212
    s_mul_i32 s33, s33, s34
    s_cmp_ge_u32 s33, 28
    s_cselect_b32 s15, s35, s32
    s_mul_i32 s28, s15, 205
    s_lshr_b32 s28, s28, 11
    s_mul_i32 s29, s28, 10
    s_sub_u32 s29, s15, s29
    s_mov_b32 s44, 0
    s_cmp_ge_u32 s15, 240
    s_cbranch_scc1 L_light
    s_cmp_ge_u32 s3, 4
    s_cbranch_scc1 L_worker_n
    v_mov_b32 v40, 33280
    v_mov_b32 v42, 0
    v_mov_b32 v43, 0
    v_mov_b32 v44, 0
    v_mov_b32 v45, 0
    s_mov_b64 exec, 1
    ds_write_b128 v40, v[42:45]
    ds_write_b128 v40, v[42:45] offset:16
    s_mov_b64 exec, -1
    s_waitcnt lgkmcnt(0)
    s_barrier
    s_load_dword s58, s[26:27], 0xf0000
    s_getpc_b64 s[32:33]
Lpc_1:
    s_sub_u32 s32, s32, Lpc_1-recurrent_scan__mha_block_cached__swiglu_ffn__decode_kernel
    s_subb_u32 s33, s33, 0
    s_lshr_b32 s34, s2, 3
    s_and_b32 s34, s34, 7
    s_lshl_b32 s34, s34, 2
    s_add_u32 s34, s34, s3
    s_lshl_b32 s34, s34, 10
    v_lshl_add_u32 v32, v1, 4, s34
    v_min_u32 v32, L_codeend-recurrent_scan__mha_block_cached__swiglu_ffn__decode_kernel-16, v32
    global_load_dwordx4 v[240:243], v32, s[32:33]
    s_waitcnt vmcnt(6)
    s_add_u32 s6, s6, 6144
    s_addc_u32 s7, s7, 0
    global_load_dwordx4 v[72:75], v2, s[6:7] offset:0 nt
    v_and_b32 v32, 1, v1
    v_lshlrev_b32 v32, 4, v32
    v_mov_b32 v33, 0xffff
    v_lshlrev_b32 v33, v32, v33
    v_bfe_u32 v34, v1, 1, 2
    v_cmp_eq_u32 s[36:37], 0, v34
    v_cmp_eq_u32 s[38:39], 1, v34
    v_cmp_eq_u32 s[40:41], 2, v34
    v_cmp_eq_u32 s[42:43], 3, v34
    s_nop 0
    v_cndmask_b32 v8, 0, v33, s[36:37]
    v_cndmask_b32 v9, 0, v33, s[38:39]
    v_cndmask_b32 v10, 0, v33, s[40:41]
    v_cndmask_b32 v11, 0, v33, s[42:43]
    v_bfe_u32 v32, v1, 4, 1
    v_lshlrev_b32 v32, 4, v32
    v_lshl_add_u32 v5, v4, 5, v32
    v_mov_b32 v6, 0xff
    s_mov_b32 s92, 0x0c0c0400
    s_mov_b32 s93, 0x0c040100
    s_mov_b32 s94, 0x04020100
    s_add_u32 s54, s26, 0x80000
    s_addc_u32 s55, s27, 0
    s_add_u32 s56, s26, 0xb0000
    s_addc_u32 s57, s27, 0
    s_waitcnt vmcnt(6)
    global_load_dwordx4 v[76:79], v2, s[6:7] offset:128 nt
    s_waitcnt vmcnt(6)
    global_load_dwordx4 v[80:83], v2, s[6:7] offset:256 nt
    s_waitcnt vmcnt(6)
    global_load_dwordx4 v[84:87], v2, s[6:7] offset:3072 nt
    s_waitcnt vmcnt(6)
    global_load_dwordx4 v[88:91], v2, s[6:7] offset:3200 nt
    s_waitcnt vmcnt(6)
    global_load_dwordx4 v[92:95], v2, s[6:7] offset:3328 nt
    s_waitcnt vmcnt(5)
    s_add_u32 s6, s6, 6144
    s_addc_u32 s7, s7, 0
    global_load_dwordx4 v[96:99], v2, s[6:7] offset:0 nt
    s_waitcnt vmcnt(5)
    global_load_dwordx4 v[100:103], v2, s[6:7] offset:128 nt
    s_waitcnt vmcnt(5)
    global_load_dwordx4 v[104:107], v2, s[6:7] offset:256 nt
    s_waitcnt vmcnt(5)
    global_load_dwordx4 v[108:111], v2, s[6:7] offset:3072 nt
    s_waitcnt vmcnt(5)
    global_load_dwordx4 v[112:115], v2, s[6:7] offset:3200 nt
    s_waitcnt vmcnt(5)
    global_load_dwordx4 v[116:119], v2, s[6:7] offset:3328 nt
    s_waitcnt vmcnt(5)
    s_add_u32 s6, s6, 6144
    s_addc_u32 s7, s7, 0
    global_load_dwordx4 v[120:123], v2, s[6:7] offset:0 nt
    s_waitcnt vmcnt(5)
    global_load_dwordx4 v[124:127], v2, s[6:7] offset:128 nt
    s_waitcnt vmcnt(5)
    global_load_dwordx4 v[128:131], v2, s[6:7] offset:256 nt
    s_waitcnt vmcnt(5)
    global_load_dwordx4 v[132:135], v2, s[6:7] offset:3072 nt
    s_waitcnt vmcnt(5)
    global_load_dwordx4 v[136:139], v2, s[6:7] offset:3200 nt
    s_waitcnt vmcnt(5)
    global_load_dwordx4 v[140:143], v2, s[6:7] offset:3328 nt
    s_waitcnt vmcnt(5)
    global_load_dwordx4 v[144:147], v2, s[8:9] offset:0 nt
    s_waitcnt vmcnt(5)
    global_load_dwordx4 v[148:151], v2, s[8:9] offset:128 nt
    s_waitcnt vmcnt(5)
    global_load_dwordx4 v[152:155], v2, s[8:9] offset:256 nt
    s_waitcnt vmcnt(5)
    global_load_dwordx4 v[156:159], v2, s[8:9] offset:3072 nt
    s_waitcnt vmcnt(5)
    global_load_dwordx4 v[160:163], v2, s[8:9] offset:3200 nt
    s_waitcnt vmcnt(5)
    global_load_dwordx4 v[164:167], v2, s[8:9] offset:3328 nt
    s_waitcnt vmcnt(5)
    s_add_u32 s8, s8, 6144
    s_addc_u32 s9, s9, 0
    global_load_dwordx4 v[168:171], v2, s[8:9] offset:0 nt
    s_waitcnt vmcnt(5)
    global_load_dwordx4 v[172:175], v2, s[8:9] offset:128 nt
    s_waitcnt vmcnt(5)
    global_load_dwordx4 v[176:179], v2, s[8:9] offset:256 nt
    s_waitcnt vmcnt(5)
    global_load_dwordx4 v[180:183], v2, s[8:9] offset:3072 nt
    s_waitcnt vmcnt(5)
    global_load_dwordx4 v[184:187], v2, s[8:9] offset:3200 nt
    s_waitcnt vmcnt(5)
    global_load_dwordx4 v[188:191], v2, s[8:9] offset:3328 nt
    s_waitcnt vmcnt(5)
    s_add_u32 s8, s8, 6144
    s_addc_u32 s9, s9, 0
    global_load_dwordx4 v[192:195], v2, s[8:9] offset:0 nt
    s_waitcnt vmcnt(5)
    global_load_dwordx4 v[196:199], v2, s[8:9] offset:128 nt
    s_waitcnt vmcnt(5)
    global_load_dwordx4 v[200:203], v2, s[8:9] offset:256 nt
    s_waitcnt vmcnt(5)
    global_load_dwordx4 v[204:207], v2, s[8:9] offset:3072 nt
    s_waitcnt vmcnt(5)
    global_load_dwordx4 v[208:211], v2, s[8:9] offset:3200 nt
    s_waitcnt vmcnt(5)
    global_load_dwordx4 v[212:215], v2, s[8:9] offset:3328 nt
    s_waitcnt vmcnt(5)
    s_add_u32 s8, s8, 6144
    s_addc_u32 s9, s9, 0
    global_load_dwordx4 v[216:219], v2, s[8:9] offset:0 nt
    s_waitcnt vmcnt(5)
    global_load_dwordx4 v[220:223], v2, s[8:9] offset:128 nt
    s_waitcnt vmcnt(5)
    global_load_dwordx4 v[224:227], v2, s[8:9] offset:256 nt
    s_waitcnt vmcnt(5)
    global_load_dwordx4 v[228:231], v2, s[8:9] offset:3072 nt
    s_waitcnt vmcnt(5)
    global_load_dwordx4 v[232:235], v2, s[8:9] offset:3200 nt
    s_waitcnt vmcnt(5)
    global_load_dwordx4 v[236:239], v2, s[8:9] offset:3328 nt
    s_waitcnt lgkmcnt(0)
    s_add_u32 s58, s58, 1
    s_and_b32 s95, s58, 0xff
    s_mul_i32 s59, s95, 0x01010101
    s_lshl_b32 s33, s28, 3
    s_add_u32 s33, s33, s3
    s_lshl_b32 s35, s29, 7
    s_mul_i32 s34, s33, 40960
    s_add_u32 s34, s34, s35
    s_add_u32 s12, s12, s34
    s_addc_u32 s13, s13, 0
    v_mov_b32 v46, 33284
Lcw_2:
    ds_read_b32 v47, v46
    s_waitcnt lgkmcnt(0)
    v_readfirstlane_b32 s32, v47
    s_add_u32 s44, s44, 1
    s_cmp_ge_u32 s32, 4
    s_cbranch_scc1 Lcok_3
    s_cmp_gt_u32 s44, 4000000
    s_cbranch_scc1 Lcok_3
    s_sleep 1
    s_branch Lcw_2
Lcok_3:
    v_lshlrev_b32 v32, 4, v4
    ds_read_b128 v[12:15], v32 offset:24576
    ds_read_b128 v[16:19], v32 offset:24704
    ds_read_b128 v[20:23], v32 offset:24832
    s_waitcnt lgkmcnt(0)
    s_waitcnt vmcnt(36)
    v_dot2_f32_bf16 v24, v48, v12, 0
    v_dot2_f32_bf16 v25, v60, v12, 0
    v_dot2_f32_bf16 v26, v72, v12, 0
    v_dot2_f32_bf16 v27, v84, v12, 0
    v_dot2_f32_bf16 v24, v49, v13, v24
    v_dot2_f32_bf16 v25, v61, v13, v25
    v_dot2_f32_bf16 v26, v73, v13, v26
    v_dot2_f32_bf16 v27, v85, v13, v27
    v_dot2_f32_bf16 v24, v50, v14, v24
    v_dot2_f32_bf16 v25, v62, v14, v25
    v_dot2_f32_bf16 v26, v74, v14, v26
    v_dot2_f32_bf16 v27, v86, v14, v27
    v_dot2_f32_bf16 v24, v51, v15, v24
    v_dot2_f32_bf16 v25, v63, v15, v25
    v_dot2_f32_bf16 v26, v75, v15, v26
    v_dot2_f32_bf16 v27, v87, v15, v27
    v_dot2_f32_bf16 v24, v52, v16, v24
    v_dot2_f32_bf16 v25, v64, v16, v25
    v_dot2_f32_bf16 v26, v76, v16, v26
    v_dot2_f32_bf16 v27, v88, v16, v27
    v_dot2_f32_bf16 v24, v53, v17, v24
    v_dot2_f32_bf16 v25, v65, v17, v25
    v_dot2_f32_bf16 v26, v77, v17, v26
    v_dot2_f32_bf16 v27, v89, v17, v27
    v_dot2_f32_bf16 v24, v54, v18, v24
    v_dot2_f32_bf16 v25, v66, v18, v25
    v_dot2_f32_bf16 v26, v78, v18, v26
    v_dot2_f32_bf16 v27, v90, v18, v27
    v_dot2_f32_bf16 v24, v55, v19, v24
    v_dot2_f32_bf16 v25, v67, v19, v25
    v_dot2_f32_bf16 v26, v79, v19, v26
    v_dot2_f32_bf16 v27, v91, v19, v27
    v_dot2_f32_bf16 v24, v56, v20, v24
    v_dot2_f32_bf16 v25, v68, v20, v25
    v_dot2_f32_bf16 v26, v80, v20, v26
    v_dot2_f32_bf16 v27, v92, v20, v27
    v_dot2_f32_bf16 v24, v57, v21, v24
    v_dot2_f32_bf16 v25, v69, v21, v25
    v_dot2_f32_bf16 v26, v81, v21, v26
    v_dot2_f32_bf16 v27, v93, v21, v27
    v_dot2_f32_bf16 v24, v58, v22, v24
    v_dot2_f32_bf16 v25, v70, v22, v25
    v_dot2_f32_bf16 v26, v82, v22, v26
    v_dot2_f32_bf16 v27, v94, v22, v27
    v_dot2_f32_bf16 v24, v59, v23, v24
    v_dot2_f32_bf16 v25, v71, v23, v25
    v_dot2_f32_bf16 v26, v83, v23, v26
    v_dot2_f32_bf16 v27, v95, v23, v27
    s_waitcnt vmcnt(24)
    v_dot2_f32_bf16 v28, v96, v12, 0
    v_dot2_f32_bf16 v29, v108, v12, 0
    v_dot2_f32_bf16 v30, v120, v12, 0
    v_dot2_f32_bf16 v31, v132, v12, 0
    v_dot2_f32_bf16 v28, v97, v13, v28
    v_dot2_f32_bf16 v29, v109, v13, v29
    v_dot2_f32_bf16 v30, v121, v13, v30
    v_dot2_f32_bf16 v31, v133, v13, v31
    v_dot2_f32_bf16 v28, v98, v14, v28
    v_dot2_f32_bf16 v29, v110, v14, v29
    v_dot2_f32_bf16 v30, v122, v14, v30
    v_dot2_f32_bf16 v31, v134, v14, v31
    v_dot2_f32_bf16 v28, v99, v15, v28
    v_dot2_f32_bf16 v29, v111, v15, v29
    v_dot2_f32_bf16 v30, v123, v15, v30
    v_dot2_f32_bf16 v31, v135, v15, v31
    v_dot2_f32_bf16 v28, v100, v16, v28
    v_dot2_f32_bf16 v29, v112, v16, v29
    v_dot2_f32_bf16 v30, v124, v16, v30
    v_dot2_f32_bf16 v31, v136, v16, v31
    v_dot2_f32_bf16 v28, v101, v17, v28
    v_dot2_f32_bf16 v29, v113, v17, v29
    v_dot2_f32_bf16 v30, v125, v17, v30
    v_dot2_f32_bf16 v31, v137, v17, v31
    v_dot2_f32_bf16 v28, v102, v18, v28
    v_dot2_f32_bf16 v29, v114, v18, v29
    v_dot2_f32_bf16 v30, v126, v18, v30
    v_dot2_f32_bf16 v31, v138, v18, v31
    v_dot2_f32_bf16 v28, v103, v19, v28
    v_dot2_f32_bf16 v29, v115, v19, v29
    v_dot2_f32_bf16 v30, v127, v19, v30
    v_dot2_f32_bf16 v31, v139, v19, v31
    v_dot2_f32_bf16 v28, v104, v20, v28
    v_dot2_f32_bf16 v29, v116, v20, v29
    v_dot2_f32_bf16 v30, v128, v20, v30
    v_dot2_f32_bf16 v31, v140, v20, v31
    v_dot2_f32_bf16 v28, v105, v21, v28
    v_dot2_f32_bf16 v29, v117, v21, v29
    v_dot2_f32_bf16 v30, v129, v21, v30
    v_dot2_f32_bf16 v31, v141, v21, v31
    v_dot2_f32_bf16 v28, v106, v22, v28
    v_dot2_f32_bf16 v29, v118, v22, v29
    v_dot2_f32_bf16 v30, v130, v22, v30
    v_dot2_f32_bf16 v31, v142, v22, v31
    v_dot2_f32_bf16 v28, v107, v23, v28
    v_dot2_f32_bf16 v29, v119, v23, v29
    v_dot2_f32_bf16 v30, v131, v23, v30
    v_dot2_f32_bf16 v31, v143, v23, v31
    s_nop 2
    v_add_f32_dpp v24, v24, v24 quad_perm:[1,0,3,2] row_mask:0xf bank_mask:0xf
    v_add_f32_dpp v25, v25, v25 quad_perm:[1,0,3,2] row_mask:0xf bank_mask:0xf
    v_add_f32_dpp v26, v26, v26 quad_perm:[1,0,3,2] row_mask:0xf bank_mask:0xf
    v_add_f32_dpp v27, v27, v27 quad_perm:[1,0,3,2] row_mask:0xf bank_mask:0xf
    v_add_f32_dpp v28, v28, v28 quad_perm:[1,0,3,2] row_mask:0xf bank_mask:0xf
    v_add_f32_dpp v29, v29, v29 quad_perm:[1,0,3,2] row_mask:0xf bank_mask:0xf
    v_add_f32_dpp v30, v30, v30 quad_perm:[1,0,3,2] row_mask:0xf bank_mask:0xf
    v_add_f32_dpp v31, v31, v31 quad_perm:[1,0,3,2] row_mask:0xf bank_mask:0xf
    v_add_f32_dpp v24, v24, v24 quad_perm:[2,3,0,1] row_mask:0xf bank_mask:0xf
    v_add_f32_dpp v25, v25, v25 quad_perm:[2,3,0,1] row_mask:0xf bank_mask:0xf
    v_add_f32_dpp v26, v26, v26 quad_perm:[2,3,0,1] row_mask:0xf bank_mask:0xf
    v_add_f32_dpp v27, v27, v27 quad_perm:[2,3,0,1] row_mask:0xf bank_mask:0xf
    v_add_f32_dpp v28, v28, v28 quad_perm:[2,3,0,1] row_mask:0xf bank_mask:0xf
    v_add_f32_dpp v29, v29, v29 quad_perm:[2,3,0,1] row_mask:0xf bank_mask:0xf
    v_add_f32_dpp v30, v30, v30 quad_perm:[2,3,0,1] row_mask:0xf bank_mask:0xf
    v_add_f32_dpp v31, v31, v31 quad_perm:[2,3,0,1] row_mask:0xf bank_mask:0xf
    v_add_f32_dpp v24, v24, v24 row_half_mirror row_mask:0xf bank_mask:0xf
    v_add_f32_dpp v25, v25, v25 row_half_mirror row_mask:0xf bank_mask:0xf
    v_add_f32_dpp v26, v26, v26 row_half_mirror row_mask:0xf bank_mask:0xf
    v_add_f32_dpp v27, v27, v27 row_half_mirror row_mask:0xf bank_mask:0xf
    v_add_f32_dpp v28, v28, v28 row_half_mirror row_mask:0xf bank_mask:0xf
    v_add_f32_dpp v29, v29, v29 row_half_mirror row_mask:0xf bank_mask:0xf
    v_add_f32_dpp v30, v30, v30 row_half_mirror row_mask:0xf bank_mask:0xf
    v_add_f32_dpp v31, v31, v31 row_half_mirror row_mask:0xf bank_mask:0xf
    s_mov_b32 s32, 0x3d93cd3a
    v_cvt_pk_bf16_f32 v32, v24, v25
    v_lshlrev_b32 v24, 16, v32
    v_and_b32 v25, 0xffff0000, v32
    v_mul_f32 v24, s32, v24
    v_mul_f32 v25, s32, v25
    v_cvt_pk_bf16_f32 v32, v24, v25
    v_lshlrev_b32 v24, 16, v32
    v_and_b32 v25, 0xffff0000, v32
    v_cvt_pk_bf16_f32 v32, v26, v27
    v_lshlrev_b32 v26, 16, v32
    v_and_b32 v27, 0xffff0000, v32
    v_mul_f32 v26, s32, v26
    v_mul_f32 v27, s32, v27
    v_cvt_pk_bf16_f32 v32, v26, v27
    v_lshlrev_b32 v26, 16, v32
    v_and_b32 v27, 0xffff0000, v32
    v_cvt_pk_bf16_f32 v32, v28, v29
    v_lshlrev_b32 v28, 16, v32
    v_and_b32 v29, 0xffff0000, v32
    v_mul_f32 v28, s32, v28
    v_mul_f32 v29, s32, v29
    v_cvt_pk_bf16_f32 v32, v28, v29
    v_lshlrev_b32 v28, 16, v32
    v_and_b32 v29, 0xffff0000, v32
    v_cvt_pk_bf16_f32 v32, v30, v31
    v_lshlrev_b32 v30, 16, v32
    v_and_b32 v31, 0xffff0000, v32
    v_mul_f32 v30, s32, v30
    v_mul_f32 v31, s32, v31
    v_cvt_pk_bf16_f32 v32, v30, v31
    v_lshlrev_b32 v30, 16, v32
    v_and_b32 v31, 0xffff0000, v32
    v_max3_f32 v32, v24, v25, v26
    v_max3_f32 v33, v27, v28, v29
    v_max3_f32 v32, v32, v30, v31
    v_max_f32 v32, v32, v33
    s_nop 1
    v_max_f32_dpp v32, v32, v32 row_ror:8 row_mask:0xf bank_mask:0xf
    s_nop 1
    v_max_f32_dpp v32, v32, v32 row_bcast:15 row_mask:0xa bank_mask:0xf
    s_nop 1
    v_max_f32_dpp v32, v32, v32 row_bcast:31 row_mask:0xc bank_mask:0xf
    s_nop 1
    v_readlane_b32 s45, v32, 63
    s_nop 1
    s_mov_b32 s32, 0x3fb8aa3b
    v_subrev_f32 v24, s45, v24
    v_mul_f32 v24, s32, v24
    v_exp_f32 v24, v24
    v_subrev_f32 v25, s45, v25
    v_mul_f32 v25, s32, v25
    v_exp_f32 v25, v25
    v_subrev_f32 v26, s45, v26
    v_mul_f32 v26, s32, v26
    v_exp_f32 v26, v26
    v_subrev_f32 v27, s45, v27
    v_mul_f32 v27, s32, v27
    v_exp_f32 v27, v27
    v_subrev_f32 v28, s45, v28
    v_mul_f32 v28, s32, v28
    v_exp_f32 v28, v28
    v_subrev_f32 v29, s45, v29
    v_mul_f32 v29, s32, v29
    v_exp_f32 v29, v29
    v_subrev_f32 v30, s45, v30
    v_mul_f32 v30, s32, v30
    v_exp_f32 v30, v30
    v_subrev_f32 v31, s45, v31
    v_mul_f32 v31, s32, v31
    v_exp_f32 v31, v31
    s_nop 0
    v_add_f32 v32, v24, v25
    v_add_f32 v33, v26, v27
    v_add_f32 v34, v28, v29
    v_add_f32 v35, v30, v31
    v_add_f32 v32, v32, v33
    v_add_f32 v34, v34, v35
    v_add_f32 v32, v32, v34
    s_nop 1
    v_add_f32_dpp v32, v32, v32 row_ror:8 row_mask:0xf bank_mask:0xf
    s_nop 1
    v_add_f32_dpp v32, v32, v32 row_bcast:15 row_mask:0xa bank_mask:0xf
    s_nop 1
    v_add_f32_dpp v32, v32, v32 row_bcast:31 row_mask:0xc bank_mask:0xf
    s_nop 1
    v_readlane_b32 s46, v32, 63
    s_nop 1
    s_lshl_b32 s32, s3, 3
    s_add_u32 s32, s32, 33312
    v_mov_b32 v32, s32
    v_mov_b32 v34, s45
    v_mov_b32 v35, s46
    s_mov_b64 exec, 1
    ds_write_b64 v32, v[34:35]
    s_mov_b64 exec, -1
    s_waitcnt lgkmcnt(0)
    v_mov_b32 v46, 33292
    v_mov_b32 v47, 1
    s_mov_b64 exec, 1
    ds_add_u32 v46, v47
    s_mov_b64 exec, -1
    v_cvt_pk_bf16_f32 v51, v24, v24
    v_and_b32 v48, v51, v8
    v_and_b32 v49, v51, v9
    v_and_b32 v50, v51, v10
    v_and_b32 v51, v51, v11
    v_cvt_pk_bf16_f32 v55, v25, v25
    v_and_b32 v52, v55, v8
    v_and_b32 v53, v55, v9
    v_and_b32 v54, v55, v10
    v_and_b32 v55, v55, v11
    v_cvt_pk_bf16_f32 v59, v26, v26
    v_and_b32 v56, v59, v8
    v_and_b32 v57, v59, v9
    v_and_b32 v58, v59, v10
    v_and_b32 v59, v59, v11
    v_cvt_pk_bf16_f32 v63, v27, v27
    v_and_b32 v60, v63, v8
    v_and_b32 v61, v63, v9
    v_and_b32 v62, v63, v10
    v_and_b32 v63, v63, v11
    v_cvt_pk_bf16_f32 v67, v28, v28
    v_and_b32 v64, v67, v8
    v_and_b32 v65, v67, v9
    v_and_b32 v66, v67, v10
    v_and_b32 v67, v67, v11
    v_cvt_pk_bf16_f32 v71, v29, v29
    v_and_b32 v68, v71, v8
    v_and_b32 v69, v71, v9
    v_and_b32 v70, v71, v10
    v_and_b32 v71, v71, v11
    v_cvt_pk_bf16_f32 v75, v30, v30
    v_and_b32 v72, v75, v8
    v_and_b32 v73, v75, v9
    v_and_b32 v74, v75, v10
    v_and_b32 v75, v75, v11
    v_cvt_pk_bf16_f32 v79, v31, v31
    v_and_b32 v76, v79, v8
    v_and_b32 v77, v79, v9
    v_and_b32 v78, v79, v10
    v_and_b32 v79, v79, v11
    s_waitcnt vmcnt(21)
    v_mfma_f32_16x16x32_bf16 v[80:83], v[48:51], v[144:147], 0
    v_mfma_f32_16x16x32_bf16 v[84:87], v[48:51], v[148:151], 0
    v_mfma_f32_16x16x32_bf16 v[88:91], v[48:51], v[152:155], 0
    s_waitcnt vmcnt(18)
    v_mfma_f32_16x16x32_bf16 v[80:83], v[52:55], v[156:159], v[80:83]
    v_mfma_f32_16x16x32_bf16 v[84:87], v[52:55], v[160:163], v[84:87]
    v_mfma_f32_16x16x32_bf16 v[88:91], v[52:55], v[164:167], v[88:91]
    s_waitcnt vmcnt(15)
    v_mfma_f32_16x16x32_bf16 v[80:83], v[56:59], v[168:171], v[80:83]
    v_mfma_f32_16x16x32_bf16 v[84:87], v[56:59], v[172:175], v[84:87]
    v_mfma_f32_16x16x32_bf16 v[88:91], v[56:59], v[176:179], v[88:91]
    s_waitcnt vmcnt(12)
    v_mfma_f32_16x16x32_bf16 v[80:83], v[60:63], v[180:183], v[80:83]
    v_mfma_f32_16x16x32_bf16 v[84:87], v[60:63], v[184:187], v[84:87]
    v_mfma_f32_16x16x32_bf16 v[88:91], v[60:63], v[188:191], v[88:91]
    s_waitcnt vmcnt(9)
    v_mfma_f32_16x16x32_bf16 v[80:83], v[64:67], v[192:195], v[80:83]
    v_mfma_f32_16x16x32_bf16 v[84:87], v[64:67], v[196:199], v[84:87]
    v_mfma_f32_16x16x32_bf16 v[88:91], v[64:67], v[200:203], v[88:91]
    s_waitcnt vmcnt(6)
    v_mfma_f32_16x16x32_bf16 v[80:83], v[68:71], v[204:207], v[80:83]
    v_mfma_f32_16x16x32_bf16 v[84:87], v[68:71], v[208:211], v[84:87]
    v_mfma_f32_16x16x32_bf16 v[88:91], v[68:71], v[212:215], v[88:91]
    s_waitcnt vmcnt(3)
    v_mfma_f32_16x16x32_bf16 v[80:83], v[72:75], v[216:219], v[80:83]
    v_mfma_f32_16x16x32_bf16 v[84:87], v[72:75], v[220:223], v[84:87]
    v_mfma_f32_16x16x32_bf16 v[88:91], v[72:75], v[224:227], v[88:91]
    s_waitcnt vmcnt(0)
    v_mfma_f32_16x16x32_bf16 v[80:83], v[76:79], v[228:231], v[80:83]
    v_mfma_f32_16x16x32_bf16 v[84:87], v[76:79], v[232:235], v[84:87]
    v_mfma_f32_16x16x32_bf16 v[88:91], v[76:79], v[236:239], v[88:91]
    s_cmp_eq_u32 s3, 1
    s_cbranch_scc0 Lskip_f_4
    v_mov_b32 v46, 33288
Lcw_5:
    ds_read_b32 v47, v46
    s_waitcnt lgkmcnt(0)
    v_readfirstlane_b32 s32, v47
    s_add_u32 s44, s44, 1
    s_cmp_ge_u32 s32, 4
    s_cbranch_scc1 Lcok_6
    s_cmp_gt_u32 s44, 4000000
    s_cbranch_scc1 Lcok_6
    s_sleep 1
    s_branch Lcw_5
Lcok_6:
    v_and_b32 v32, 3, v1
    v_lshlrev_b32 v32, 9, v32
    v_lshrrev_b32 v33, 2, v1
    v_lshl_add_u32 v32, v33, 4, v32
    ds_read_b128 v[240:243], v32 offset:25088
    ds_read_b128 v[244:247], v32 offset:25344
    s_mul_i32 s35, s15, 640
    s_add_u32 s35, s35, 384
    v_lshlrev_b32 v33, 4, v33
    v_add_u32 v33, s35, v33
    s_waitcnt lgkmcnt(0)
    v_pk_add_f32 v[240:241], v[240:241], v[244:245]
    v_pk_add_f32 v[242:243], v[242:243], v[246:247]
    s_nop 1
    v_add_f32_dpp v240, v240, v240 quad_perm:[1,0,3,2] row_mask:0xf bank_mask:0xf
    v_add_f32_dpp v241, v241, v241 quad_perm:[1,0,3,2] row_mask:0xf bank_mask:0xf
    v_add_f32_dpp v242, v242, v242 quad_perm:[1,0,3,2] row_mask:0xf bank_mask:0xf
    v_add_f32_dpp v243, v243, v243 quad_perm:[1,0,3,2] row_mask:0xf bank_mask:0xf
    v_add_f32_dpp v240, v240, v240 quad_perm:[2,3,0,1] row_mask:0xf bank_mask:0xf
    v_add_f32_dpp v241, v241, v241 quad_perm:[2,3,0,1] row_mask:0xf bank_mask:0xf
    v_add_f32_dpp v242, v242, v242 quad_perm:[2,3,0,1] row_mask:0xf bank_mask:0xf
    v_add_f32_dpp v243, v243, v243 quad_perm:[2,3,0,1] row_mask:0xf bank_mask:0xf
    v_bfi_b32 v240, v6, s95, v240
    v_bfi_b32 v241, v6, s95, v241
    v_bfi_b32 v242, v6, s95, v242
    v_bfi_b32 v243, v6, s95, v243
    s_mov_b32 exec_lo, 0x11111111
    s_mov_b32 exec_hi, 0x11111111
    global_store_dwordx4 v33, v[240:243], s[56:57] sc1
    s_mov_b64 exec, -1
Lskip_f_4:
    v_mov_b32 v46, 33292
Lcw_7:
    ds_read_b32 v47, v46
    s_waitcnt lgkmcnt(0)
    v_readfirstlane_b32 s32, v47
    s_add_u32 s44, s44, 1
    s_cmp_ge_u32 s32, 8
    s_cbranch_scc1 Lcok_8
    s_cmp_gt_u32 s44, 4000000
    s_cbranch_scc1 Lcok_8
    s_sleep 1
    s_branch Lcw_7
Lcok_8:
    v_lshlrev_b32 v32, 3, v4
    ds_read_b64 v[34:35], v32 offset:33312
    s_waitcnt lgkmcnt(0)
    v_mov_b32 v36, v34
    s_nop 1
    s_nop 1
    v_max_f32_dpp v36, v36, v36 quad_perm:[1,0,3,2] row_mask:0xf bank_mask:0xf
    s_nop 1
    v_max_f32_dpp v36, v36, v36 quad_perm:[2,3,0,1] row_mask:0xf bank_mask:0xf
    s_nop 1
    v_max_f32_dpp v36, v36, v36 row_half_mirror row_mask:0xf bank_mask:0xf
    s_mov_b32 s32, 0x3fb8aa3b
    v_sub_f32 v7, s45, v36
    v_mul_f32 v7, s32, v7
    v_exp_f32 v7, v7
    s_cmp_eq_u32 s3, 0
    s_cbranch_scc0 Lskip_ml_9
    v_sub_f32 v37, v34, v36
    v_mul_f32 v37, s32, v37
    v_exp_f32 v37, v37
    s_nop 0
    v_mul_f32 v37, v37, v35
    s_nop 1
    s_nop 1
    v_add_f32_dpp v37, v37, v37 quad_perm:[1,0,3,2] row_mask:0xf bank_mask:0xf
    s_nop 1
    v_add_f32_dpp v37, v37, v37 quad_perm:[2,3,0,1] row_mask:0xf bank_mask:0xf
    s_nop 1
    v_add_f32_dpp v37, v37, v37 row_half_mirror row_mask:0xf bank_mask:0xf
    v_mov_b32 v38, v36
    v_mov_b32 v39, v37
    v_bfi_b32 v36, v6, s95, v36
    v_bfi_b32 v37, v6, s95, v37
    v_bfi_b32 v38, v6, s95, v38
    v_bfi_b32 v39, v6, s95, v39
    s_lshl_b32 s33, s30, 3
    s_add_u32 s33, s33, s31
    s_mul_i32 s33, s33, 640
    v_mov_b32 v32, s33
    s_mov_b64 exec, 1
    global_store_dwordx4 v32, v[36:39], s[56:57] sc1
    s_mov_b64 exec, -1
Lskip_ml_9:
    v_lshrrev_b32 v32, 5, v1
    s_lshl_b32 s32, s3, 1
    v_add_u32 v32, s32, v32
    v_mul_u32_u24 v32, 768, v32
    v_add_u32 v32, v32, v5
    s_nop 3
    v_mul_f32 v80, v7, v80
    v_mul_f32 v81, v7, v81
    v_mul_f32 v82, v7, v82
    v_mul_f32 v83, v7, v83
    v_mul_f32 v84, v7, v84
    v_mul_f32 v85, v7, v85
    v_mul_f32 v86, v7, v86
    v_mul_f32 v87, v7, v87
    v_mul_f32 v88, v7, v88
    v_mul_f32 v89, v7, v89
    v_mul_f32 v90, v7, v90
    v_mul_f32 v91, v7, v91
    s_mov_b32 exec_lo, 0x00ff00ff
    s_mov_b32 exec_hi, 0xff00ff00
    ds_write_b128 v32, v[80:83] offset:0
    ds_write_b128 v32, v[84:87] offset:256
    ds_write_b128 v32, v[88:91] offset:512
    s_mov_b64 exec, -1
    v_mov_b32 v46, 33296
Lcw_10:
    ds_read_b32 v47, v46
    s_waitcnt lgkmcnt(0)
    v_readfirstlane_b32 s32, v47
    s_add_u32 s44, s44, 1
    s_cmp_ge_u32 s32, 4
    s_cbranch_scc1 Lcok_11
    s_cmp_gt_u32 s44, 4000000
    s_cbranch_scc1 Lcok_11
    s_sleep 1
    s_branch Lcw_10
Lcok_11:
    s_setprio 3
    v_mul_u32_u24 v253, 5120, v3
    v_lshl_add_u32 v253, v4, 4, v253
    global_load_dwordx4 v[96:99], v253, s[12:13] offset:0 nt
    global_load_dwordx4 v[100:103], v253, s[12:13] offset:1280 nt
    global_load_dwordx4 v[104:107], v253, s[12:13] offset:2560 nt
    global_load_dwordx4 v[108:111], v253, s[12:13] offset:3840 nt
    s_setprio 1
    s_branch L_tail_n
L_worker_n:
    s_sub_u32 s49, s3, 4
    s_mul_i32 s53, s15, 205
    s_lshr_b32 s53, s53, 10
    s_mul_i32 s14, s53, 5
    s_sub_u32 s14, s15, s14
    s_cmp_lt_u32 s53, 40
    s_cselect_b32 s50, s16, s18
    s_cselect_b32 s51, s17, s19
    s_cselect_b32 s33, 32, 40
    s_cmp_lt_u32 s53, 32
    s_cselect_b32 s50, s10, s50
    s_cselect_b32 s51, s11, s51
    s_cselect_b32 s33, 0, s33
    s_cselect_b32 s52, 2, 0
    s_lshl_b32 s52, 3072, s52
    s_sub_u32 s33, s53, s33
    s_mul_i32 s33, s33, 384
    s_lshl_b32 s32, s14, 2
    s_add_u32 s32, s32, s49
    s_lshl_b32 s32, s32, 5
    s_mul_i32 s34, s32, s52
    s_add_u32 s33, s33, s34
    s_add_u32 s50, s50, s33
    s_addc_u32 s51, s51, 0
    v_mul_u32_u24 v248, s52, v3
    v_lshl_add_u32 v248, v4, 4, v248
    s_lshl_b32 s52, s52, 3
    v_lshlrev_b32 v32, 2, v1
    global_load_dword v240, v32, s[4:5] offset:0
    global_load_dword v241, v32, s[4:5] offset:256
    global_load_dword v242, v32, s[4:5] offset:512
    global_load_dword v243, v32, s[4:5] offset:768
    global_load_dword v244, v32, s[4:5] offset:1024
    v_add_u32 v33, s32, v3
    v_lshlrev_b32 v33, 1, v33
    global_load_ushort v12, v33, s[4:5] offset:0
    global_load_ushort v13, v33, s[4:5] offset:16
    global_load_ushort v14, v33, s[4:5] offset:32
    global_load_ushort v15, v33, s[4:5] offset:48
    global_load_dwordx4 v[144:147], v248, s[50:51] offset:0 nt
    global_load_dwordx4 v[148:151], v248, s[50:51] offset:128 nt
    global_load_dwordx4 v[152:155], v248, s[50:51] offset:256 nt
    v_mov_b32 v40, 33280
    v_mov_b32 v42, 0
    v_mov_b32 v43, 0
    v_mov_b32 v44, 0
    v_mov_b32 v45, 0
    s_mov_b64 exec, 1
    ds_write_b128 v40, v[42:45]
    ds_write_b128 v40, v[42:45] offset:16
    s_mov_b64 exec, -1
    s_waitcnt lgkmcnt(0)
    s_barrier
    s_load_dword s58, s[26:27], 0xf0000
    v_add_u32 v248, s52, v248
    global_load_dwordx4 v[156:159], v248, s[50:51] offset:0 nt
    global_load_dwordx4 v[160:163], v248, s[50:51] offset:128 nt
    global_load_dwordx4 v[164:167], v248, s[50:51] offset:256 nt
    v_add_u32 v248, s52, v248
    global_load_dwordx4 v[168:171], v248, s[50:51] offset:0 nt
    global_load_dwordx4 v[172:175], v248, s[50:51] offset:128 nt
    global_load_dwordx4 v[176:179], v248, s[50:51] offset:256 nt
    v_add_u32 v248, s52, v248
    global_load_dwordx4 v[180:183], v248, s[50:51] offset:0 nt
    global_load_dwordx4 v[184:187], v248, s[50:51] offset:128 nt
    global_load_dwordx4 v[188:191], v248, s[50:51] offset:256 nt
    s_lshl_b32 s33, s28, 2
    s_add_u32 s33, s33, s49
    s_mul_i32 s34, s33, 20480
    s_lshl_b32 s35, s29, 7
    s_add_u32 s34, s34, s35
    s_add_u32 s20, s20, s34
    s_addc_u32 s21, s21, 0
    v_and_b32 v32, 1, v1
    v_lshlrev_b32 v32, 4, v32
    v_mov_b32 v33, 0xffff
    v_lshlrev_b32 v33, v32, v33
    v_bfe_u32 v34, v1, 1, 2
    v_cmp_eq_u32 s[36:37], 0, v34
    v_cmp_eq_u32 s[38:39], 1, v34
    v_cmp_eq_u32 s[40:41], 2, v34
    v_cmp_eq_u32 s[42:43], 3, v34
    s_nop 0
    v_cndmask_b32 v8, 0, v33, s[36:37]
    v_cndmask_b32 v9, 0, v33, s[38:39]
    v_cndmask_b32 v10, 0, v33, s[40:41]
    v_cndmask_b32 v11, 0, v33, s[42:43]
    v_bfe_u32 v32, v1, 4, 1
    v_lshlrev_b32 v32, 4, v32
    v_lshl_add_u32 v5, v4, 5, v32
    v_mov_b32 v6, 0xff
    s_mov_b32 s92, 0x0c0c0400
    s_mov_b32 s93, 0x0c040100
    s_mov_b32 s94, 0x04020100
    s_add_u32 s54, s26, 0x80000
    s_addc_u32 s55, s27, 0
    s_add_u32 s56, s26, 0xb0000
    s_addc_u32 s57, s27, 0
    s_waitcnt vmcnt(12)
    v_lshlrev_b32 v246, 16, v240
    v_and_b32 v247, 0xffff0000, v240
    v_lshlrev_b32 v248, 16, v241
    v_and_b32 v249, 0xffff0000, v241
    v_lshlrev_b32 v250, 16, v242
    v_and_b32 v251, 0xffff0000, v242
    v_lshlrev_b32 v252, 16, v243
    v_and_b32 v253, 0xffff0000, v243
    v_lshlrev_b32 v254, 16, v244
    v_and_b32 v255, 0xffff0000, v244
    v_add_f32 v32, v246, v247
    v_add_f32 v32, v32, v248
    v_add_f32 v32, v32, v249
    v_add_f32 v32, v32, v250
    v_add_f32 v32, v32, v251
    v_add_f32 v32, v32, v252
    v_add_f32 v32, v32, v253
    v_add_f32 v32, v32, v254
    v_add_f32 v32, v32, v255
    s_nop 1
    v_add_f32_dpp v32, v32, v32 quad_perm:[1,0,3,2] row_mask:0xf bank_mask:0xf
    s_nop 1
    v_add_f32_dpp v32, v32, v32 quad_perm:[2,3,0,1] row_mask:0xf bank_mask:0xf
    s_nop 1
    v_add_f32_dpp v32, v32, v32 row_half_mirror row_mask:0xf bank_mask:0xf
    s_nop 1
    v_add_f32_dpp v32, v32, v32 row_mirror row_mask:0xf bank_mask:0xf
    s_nop 1
    v_add_f32_dpp v32, v32, v32 row_bcast:15 row_mask:0xa bank_mask:0xf
    s_nop 1
    v_add_f32_dpp v32, v32, v32 row_bcast:31 row_mask:0xc bank_mask:0xf
    s_nop 1
    v_readlane_b32 s32, v32, 63
    s_nop 1
    v_mov_b32 v33, 0x3acccccd
    v_mul_f32 v34, s32, v33
    v_sub_f32 v246, v246, v34
    v_mul_f32 v32, v246, v246
    v_sub_f32 v247, v247, v34
    v_fmac_f32 v32, v247, v247
    v_sub_f32 v248, v248, v34
    v_fmac_f32 v32, v248, v248
    v_sub_f32 v249, v249, v34
    v_fmac_f32 v32, v249, v249
    v_sub_f32 v250, v250, v34
    v_fmac_f32 v32, v250, v250
    v_sub_f32 v251, v251, v34
    v_fmac_f32 v32, v251, v251
    v_sub_f32 v252, v252, v34
    v_fmac_f32 v32, v252, v252
    v_sub_f32 v253, v253, v34
    v_fmac_f32 v32, v253, v253
    v_sub_f32 v254, v254, v34
    v_fmac_f32 v32, v254, v254
    v_sub_f32 v255, v255, v34
    v_fmac_f32 v32, v255, v255
    s_nop 1
    v_add_f32_dpp v32, v32, v32 quad_perm:[1,0,3,2] row_mask:0xf bank_mask:0xf
    s_nop 1
    v_add_f32_dpp v32, v32, v32 quad_perm:[2,3,0,1] row_mask:0xf bank_mask:0xf
    s_nop 1
    v_add_f32_dpp v32, v32, v32 row_half_mirror row_mask:0xf bank_mask:0xf
    s_nop 1
    v_add_f32_dpp v32, v32, v32 row_mirror row_mask:0xf bank_mask:0xf
    s_nop 1
    v_add_f32_dpp v32, v32, v32 row_bcast:15 row_mask:0xa bank_mask:0xf
    s_nop 1
    v_add_f32_dpp v32, v32, v32 row_bcast:31 row_mask:0xc bank_mask:0xf
    s_nop 1
    v_readlane_b32 s32, v32, 63
    s_nop 1
    v_mul_f32 v35, s32, v33
    v_cvt_pk_bf16_f32 v34, v34, v34
    v_and_b32 v34, 0xffff0000, v34
    v_cvt_pk_bf16_f32 v35, v35, v35
    v_and_b32 v35, 0xffff0000, v35
    v_add_f32 v35, 0x3727c5ac, v35
    v_cvt_pk_bf16_f32 v35, v35, v35
    v_and_b32 v35, 0xffff0000, v35
    v_sqrt_f32 v35, v35
    s_nop 0
    v_cvt_pk_bf16_f32 v35, v35, v35
    v_and_b32 v35, 0xffff0000, v35
    v_rcp_f32 v37, v35
    v_lshlrev_b32 v36, 16, v12
    v_sub_f32 v36, v36, v34
    v_cvt_pk_bf16_f32 v36, v36, v36
    v_and_b32 v36, 0xffff0000, v36
    v_mul_f32 v38, v36, v37
    v_fma_f32 v39, -v38, v35, v36
    v_fma_f32 v128, v39, v37, v38
    v_lshlrev_b32 v36, 16, v13
    v_sub_f32 v36, v36, v34
    v_cvt_pk_bf16_f32 v36, v36, v36
    v_and_b32 v36, 0xffff0000, v36
    v_mul_f32 v38, v36, v37
    v_fma_f32 v39, -v38, v35, v36
    v_fma_f32 v129, v39, v37, v38
    v_lshlrev_b32 v36, 16, v14
    v_sub_f32 v36, v36, v34
    v_cvt_pk_bf16_f32 v36, v36, v36
    v_and_b32 v36, 0xffff0000, v36
    v_mul_f32 v38, v36, v37
    v_fma_f32 v39, -v38, v35, v36
    v_fma_f32 v130, v39, v37, v38
    v_lshlrev_b32 v36, 16, v15
    v_sub_f32 v36, v36, v34
    v_cvt_pk_bf16_f32 v36, v36, v36
    v_and_b32 v36, 0xffff0000, v36
    v_mul_f32 v38, v36, v37
    v_fma_f32 v39, -v38, v35, v36
    v_fma_f32 v131, v39, v37, v38
    v_cvt_pk_bf16_f32 v27, v128, v128
    v_and_b32 v24, v27, v8
    v_and_b32 v25, v27, v9
    v_and_b32 v26, v27, v10
    v_and_b32 v27, v27, v11
    v_cvt_pk_bf16_f32 v31, v129, v129
    v_and_b32 v28, v31, v8
    v_and_b32 v29, v31, v9
    v_and_b32 v30, v31, v10
    v_and_b32 v31, v31, v11
    v_cvt_pk_bf16_f32 v19, v130, v130
    v_and_b32 v16, v19, v8
    v_and_b32 v17, v19, v9
    v_and_b32 v18, v19, v10
    v_and_b32 v19, v19, v11
    v_cvt_pk_bf16_f32 v23, v131, v131
    v_and_b32 v20, v23, v8
    v_and_b32 v21, v23, v9
    v_and_b32 v22, v23, v10
    v_and_b32 v23, v23, v11
    s_waitcnt vmcnt(0)
    v_mfma_f32_16x16x32_bf16 v[192:195], v[24:27], v[144:147], 0
    v_mfma_f32_16x16x32_bf16 v[196:199], v[24:27], v[148:151], 0
    v_mfma_f32_16x16x32_bf16 v[200:203], v[24:27], v[152:155], 0
    v_mfma_f32_16x16x32_bf16 v[192:195], v[28:31], v[156:159], v[192:195]
    v_mfma_f32_16x16x32_bf16 v[196:199], v[28:31], v[160:163], v[196:199]
    v_mfma_f32_16x16x32_bf16 v[200:203], v[28:31], v[164:167], v[200:203]
    v_mfma_f32_16x16x32_bf16 v[192:195], v[16:19], v[168:171], v[192:195]
    v_mfma_f32_16x16x32_bf16 v[196:199], v[16:19], v[172:175], v[196:199]
    v_mfma_f32_16x16x32_bf16 v[200:203], v[16:19], v[176:179], v[200:203]
    v_mfma_f32_16x16x32_bf16 v[192:195], v[20:23], v[180:183], v[192:195]
    v_mfma_f32_16x16x32_bf16 v[196:199], v[20:23], v[184:187], v[196:199]
    v_mfma_f32_16x16x32_bf16 v[200:203], v[20:23], v[188:191], v[200:203]
    v_lshrrev_b32 v32, 5, v1
    s_lshl_b32 s32, s49, 1
    v_add_u32 v32, s32, v32
    v_mul_u32_u24 v32, 768, v32
    v_add_u32 v32, v32, v5
    v_and_b32 v34, 3, v1
    v_mul_u32_u24 v34, 1536, v34
    v_lshrrev_b32 v38, 2, v1
    s_mul_i32 s35, s15, 1024
    s_mov_b32 exec_lo, 0x00ff00ff
    s_mov_b32 exec_hi, 0xff00ff00
    ds_write_b128 v32, v[192:195] offset:0
    ds_write_b128 v32, v[196:199] offset:256
    ds_write_b128 v32, v[200:203] offset:512
    s_mov_b64 exec, -1
    s_waitcnt lgkmcnt(0)
    v_mov_b32 v46, 33280
    v_mov_b32 v47, 1
    s_mov_b64 exec, 1
    ds_add_u32 v46, v47
    s_mov_b64 exec, -1
    s_add_u32 s58, s58, 1
    s_and_b32 s95, s58, 0xff
    s_mul_i32 s59, s95, 0x01010101
    s_cmp_lt_u32 s53, 32
    s_cbranch_scc0 Lpq_gu_12
    s_mul_i32 s33, s49, 192
    v_mul_u32_u24 v35, 12, v38
    v_add_u32 v35, v35, v34
    v_add_u32 v35, s33, v35
    s_lshl_b32 s33, s49, 8
    s_add_u32 s33, s33, s35
    v_lshl_add_u32 v37, v38, 4, s33
    v_mov_b32 v46, 33280
Lcw_14:
    ds_read_b32 v47, v46
    s_waitcnt lgkmcnt(0)
    v_readfirstlane_b32 s32, v47
    s_add_u32 s44, s44, 1
    s_cmp_ge_u32 s32, 4
    s_cbranch_scc1 Lcok_15
    s_cmp_gt_u32 s44, 4000000
    s_cbranch_scc1 Lcok_15
    s_sleep 1
    s_branch Lcw_14
Lcok_15:
    ds_read2_b32 v[192:193], v35 offset0:0 offset1:1
    ds_read_b32 v194, v35 offset:8
    ds_read2_b32 v[196:197], v35 offset0:192 offset1:193
    ds_read_b32 v198, v35 offset:776
    s_waitcnt lgkmcnt(0)
    v_add_f32 v192, v192, v196
    v_add_f32 v193, v193, v197
    v_add_f32 v194, v194, v198
    v_mov_b32 v195, s58
    v_add_f32_dpp v192, v192, v192 quad_perm:[1,0,3,2] row_mask:0xf bank_mask:0xf
    v_add_f32_dpp v193, v193, v193 quad_perm:[1,0,3,2] row_mask:0xf bank_mask:0xf
    v_add_f32_dpp v194, v194, v194 quad_perm:[1,0,3,2] row_mask:0xf bank_mask:0xf
    v_add_f32_dpp v192, v192, v192 quad_perm:[2,3,0,1] row_mask:0xf bank_mask:0xf
    v_add_f32_dpp v193, v193, v193 quad_perm:[2,3,0,1] row_mask:0xf bank_mask:0xf
    v_add_f32_dpp v194, v194, v194 quad_perm:[2,3,0,1] row_mask:0xf bank_mask:0xf
    s_mov_b32 exec_lo, 0x11111111
    s_mov_b32 exec_hi, 0x11111111
    global_store_dwordx4 v37, v[192:195], s[26:27] sc1
    s_mov_b64 exec, -1
    s_branch Lpq_join_13
Lpq_gu_12:
    v_min_u32 v38, 11, v38
    s_mul_i32 s33, s49, 12
    v_add_u32 v38, s33, v38
    v_lshl_add_u32 v35, v38, 4, v34
    v_lshl_add_u32 v37, v38, 4, s35
    v_mov_b32 v46, 33280
Lcw_16:
    ds_read_b32 v47, v46
    s_waitcnt lgkmcnt(0)
    v_readfirstlane_b32 s32, v47
    s_add_u32 s44, s44, 1
    s_cmp_ge_u32 s32, 4
    s_cbranch_scc1 Lcok_17
    s_cmp_gt_u32 s44, 4000000
    s_cbranch_scc1 Lcok_17
    s_sleep 1
    s_branch Lcw_16
Lcok_17:
    ds_read_b128 v[192:195], v35 offset:0
    ds_read_b128 v[196:199], v35 offset:768
    s_waitcnt lgkmcnt(0)
    v_pk_add_f32 v[192:193], v[192:193], v[196:197]
    v_pk_add_f32 v[194:195], v[194:195], v[198:199]
    s_nop 1
    v_add_f32_dpp v192, v192, v192 quad_perm:[1,0,3,2] row_mask:0xf bank_mask:0xf
    v_add_f32_dpp v193, v193, v193 quad_perm:[1,0,3,2] row_mask:0xf bank_mask:0xf
    v_add_f32_dpp v194, v194, v194 quad_perm:[1,0,3,2] row_mask:0xf bank_mask:0xf
    v_add_f32_dpp v195, v195, v195 quad_perm:[1,0,3,2] row_mask:0xf bank_mask:0xf
    v_add_f32_dpp v192, v192, v192 quad_perm:[2,3,0,1] row_mask:0xf bank_mask:0xf
    v_add_f32_dpp v193, v193, v193 quad_perm:[2,3,0,1] row_mask:0xf bank_mask:0xf
    v_add_f32_dpp v194, v194, v194 quad_perm:[2,3,0,1] row_mask:0xf bank_mask:0xf
    v_add_f32_dpp v195, v195, v195 quad_perm:[2,3,0,1] row_mask:0xf bank_mask:0xf
    v_bfi_b32 v192, v6, s95, v192
    v_bfi_b32 v193, v6, s95, v193
    v_bfi_b32 v194, v6, s95, v194
    v_bfi_b32 v195, v6, s95, v195
    s_mov_b32 exec_lo, 0x11111111
    s_mov_b32 exec_hi, 0x00001111
    global_store_dwordx4 v37, v[192:195], s[26:27] sc1
    s_mov_b64 exec, -1
Lpq_join_13:
    v_mul_u32_u24 v250, 1280, v3
    v_lshl_add_u32 v250, v4, 4, v250
    global_load_dwordx4 v[232:235], v250, s[20:21] offset:0 nt
    v_add_u32 v250, 10240, v250
    global_load_dwordx4 v[236:239], v250, s[20:21] offset:0 nt
    s_lshl_b32 s33, s28, 3
    s_add_u32 s33, s33, s3
    s_lshl_b32 s35, s29, 7
    s_mul_i32 s34, s33, 40960
    s_add_u32 s34, s34, s35
    s_add_u32 s12, s12, s34
    s_addc_u32 s13, s13, 0
    global_load_dwordx4 v[48:51], v2, s[6:7] offset:0 nt
    global_load_dwordx4 v[52:55], v2, s[6:7] offset:128 nt
    global_load_dwordx4 v[56:59], v2, s[6:7] offset:256 nt
    global_load_dwordx4 v[60:63], v2, s[6:7] offset:3072 nt
    global_load_dwordx4 v[64:67], v2, s[6:7] offset:3200 nt
    global_load_dwordx4 v[68:71], v2, s[6:7] offset:3328 nt
    s_add_u32 s6, s6, 6144
    s_addc_u32 s7, s7, 0
    global_load_dwordx4 v[72:75], v2, s[6:7] offset:0 nt
    global_load_dwordx4 v[76:79], v2, s[6:7] offset:128 nt
    global_load_dwordx4 v[80:83], v2, s[6:7] offset:256 nt
    global_load_dwordx4 v[84:87], v2, s[6:7] offset:3072 nt
    global_load_dwordx4 v[88:91], v2, s[6:7] offset:3200 nt
    global_load_dwordx4 v[92:95], v2, s[6:7] offset:3328 nt
    s_setprio 1
    s_add_u32 s6, s6, 6144
    s_addc_u32 s7, s7, 0
    global_load_dwordx4 v[96:99], v2, s[6:7] offset:0 nt
    global_load_dwordx4 v[100:103], v2, s[6:7] offset:128 nt
    global_load_dwordx4 v[104:107], v2, s[6:7] offset:256 nt
    global_load_dwordx4 v[108:111], v2, s[6:7] offset:3072 nt
    global_load_dwordx4 v[112:115], v2, s[6:7] offset:3200 nt
    global_load_dwordx4 v[116:119], v2, s[6:7] offset:3328 nt
    s_add_u32 s6, s6, 6144
    s_addc_u32 s7, s7, 0
    global_load_dwordx4 v[120:123], v2, s[6:7] offset:0 nt
    global_load_dwordx4 v[124:127], v2, s[6:7] offset:128 nt
    global_load_dwordx4 v[128:131], v2, s[6:7] offset:256 nt
    global_load_dwordx4 v[132:135], v2, s[6:7] offset:3072 nt
    global_load_dwordx4 v[136:139], v2, s[6:7] offset:3200 nt
    global_load_dwordx4 v[140:143], v2, s[6:7] offset:3328 nt
    s_mul_i32 s32, s30, 5120
    s_lshl_b32 s33, s49, 8
    s_add_u32 s32, s32, s33
    v_min_u32 v33, 4, v4
    v_mul_u32_u24 v33, 1024, v33
    v_lshl_add_u32 v34, v3, 4, v33
    v_add_u32 v248, s32, v34
    s_mul_i32 s32, s28, 171
    s_lshr_b32 s32, s32, 9
    s_mul_i32 s33, s32, 3
    s_sub_u32 s33, s28, s33
    s_add_u32 s32, s32, 32
    s_mul_i32 s32, s32, 5120
    s_lshl_b32 s33, s33, 8
    s_add_u32 s32, s32, s33
    s_lshl_b32 s33, s49, 6
    s_add_u32 s32, s32, s33
    v_lshrrev_b32 v34, 2, v3
    v_lshl_add_u32 v34, v34, 4, v33
    v_add_u32 v249, s32, v34
    v_add_u32 v250, 40960, v249
    v_mov_b32 v240, 0
    v_mov_b32 v241, 0
    v_mov_b32 v242, 0
    v_mov_b32 v243, s58
    v_mov_b32 v244, 0
    v_mov_b32 v245, 0
    v_mov_b32 v246, 0
    v_mov_b32 v247, s58
    v_mov_b32 v208, s95
    v_mov_b32 v209, s95
    v_mov_b32 v210, s95
    v_mov_b32 v211, s95
    v_mov_b32 v212, s95
    v_mov_b32 v213, s95
    v_mov_b32 v214, s95
    v_mov_b32 v215, s95
    v_mov_b32 v216, s95
    v_mov_b32 v217, s95
    v_mov_b32 v218, s95
    v_mov_b32 v219, s95
    v_mov_b32 v220, s95
    v_mov_b32 v221, s95
    v_mov_b32 v222, s95
    v_mov_b32 v223, s95
    s_mov_b32 exec_lo, 0x1f1f1f1f
    s_mov_b32 exec_hi, 0x1f1f1f1f
    global_load_dwordx4 v[240:243], v248, s[26:27] offset:0 sc1
    global_load_dwordx4 v[244:247], v248, s[26:27] offset:128 sc1
    global_load_dwordx4 v[208:211], v249, s[26:27] sc1
    global_load_dwordx4 v[212:215], v249, s[26:27] offset:32 sc1
    global_load_dwordx4 v[216:219], v250, s[26:27] sc1
    global_load_dwordx4 v[220:223], v250, s[26:27] offset:32 sc1
    s_mov_b64 exec, -1
    global_load_dwordx4 v[144:147], v2, s[8:9] offset:0 nt
    global_load_dwordx4 v[148:151], v2, s[8:9] offset:128 nt
    global_load_dwordx4 v[152:155], v2, s[8:9] offset:256 nt
    global_load_dwordx4 v[156:159], v2, s[8:9] offset:3072 nt
    global_load_dwordx4 v[160:163], v2, s[8:9] offset:3200 nt
    global_load_dwordx4 v[164:167], v2, s[8:9] offset:3328 nt
    s_add_u32 s8, s8, 6144
    s_addc_u32 s9, s9, 0
    global_load_dwordx4 v[168:171], v2, s[8:9] offset:0 nt
    global_load_dwordx4 v[172:175], v2, s[8:9] offset:128 nt
    global_load_dwordx4 v[176:179], v2, s[8:9] offset:256 nt
    global_load_dwordx4 v[180:183], v2, s[8:9] offset:3072 nt
    s_waitcnt vmcnt(10)
    v_xor_b32 v34, s58, v243
    v_xor_b32 v35, s58, v247
    v_or_b32 v34, v34, v35
    v_perm_b32 v32, v209, v208, s92
    v_perm_b32 v32, v210, v32, s93
    v_perm_b32 v32, v211, v32, s94
    v_xor_b32 v32, s59, v32
    v_or_b32 v34, v34, v32
    v_perm_b32 v32, v213, v212, s92
    v_perm_b32 v32, v214, v32, s93
    v_perm_b32 v32, v215, v32, s94
    v_xor_b32 v32, s59, v32
    v_or_b32 v34, v34, v32
    v_perm_b32 v32, v217, v216, s92
    v_perm_b32 v32, v218, v32, s93
    v_perm_b32 v32, v219, v32, s94
    v_xor_b32 v32, s59, v32
    v_or_b32 v34, v34, v32
    v_perm_b32 v32, v221, v220, s92
    v_perm_b32 v32, v222, v32, s93
    v_perm_b32 v32, v223, v32, s94
    v_xor_b32 v32, s59, v32
    v_or_b32 v34, v34, v32
    v_cmp_ne_u32 vcc, 0, v34
    s_cbranch_vccz Lok_q_18
Lre_q_19:
    s_add_u32 s44, s44, 1
    s_cmp_gt_u32 s44, 200000
    s_cbranch_scc1 Lok_q_18
    s_sleep 2
    s_mov_b64 exec, vcc
    global_load_dwordx4 v[240:243], v248, s[26:27] offset:0 sc1
    global_load_dwordx4 v[244:247], v248, s[26:27] offset:128 sc1
    global_load_dwordx4 v[208:211], v249, s[26:27] sc1
    global_load_dwordx4 v[212:215], v249, s[26:27] offset:32 sc1
    global_load_dwordx4 v[216:219], v250, s[26:27] sc1
    global_load_dwordx4 v[220:223], v250, s[26:27] offset:32 sc1
    s_mov_b64 exec, -1
    s_waitcnt vmcnt(0)
    v_xor_b32 v34, s58, v243
    v_xor_b32 v35, s58, v247
    v_or_b32 v34, v34, v35
    v_perm_b32 v32, v209, v208, s92
    v_perm_b32 v32, v210, v32, s93
    v_perm_b32 v32, v211, v32, s94
    v_xor_b32 v32, s59, v32
    v_or_b32 v34, v34, v32
    v_perm_b32 v32, v213, v212, s92
    v_perm_b32 v32, v214, v32, s93
    v_perm_b32 v32, v215, v32, s94
    v_xor_b32 v32, s59, v32
    v_or_b32 v34, v34, v32
    v_perm_b32 v32, v217, v216, s92
    v_perm_b32 v32, v218, v32, s93
    v_perm_b32 v32, v219, v32, s94
    v_xor_b32 v32, s59, v32
    v_or_b32 v34, v34, v32
    v_perm_b32 v32, v221, v220, s92
    v_perm_b32 v32, v222, v32, s93
    v_perm_b32 v32, v223, v32, s94
    v_xor_b32 v32, s59, v32
    v_or_b32 v34, v34, v32
    v_cmp_ne_u32 vcc, 0, v34
    s_cbranch_vccnz Lre_q_19
Lok_q_18:
    v_add_f32_dpp v240, v240, v240 quad_perm:[1,0,3,2] row_mask:0xf bank_mask:0xf
    v_add_f32_dpp v241, v241, v241 quad_perm:[1,0,3,2] row_mask:0xf bank_mask:0xf
    v_add_f32_dpp v242, v242, v242 quad_perm:[1,0,3,2] row_mask:0xf bank_mask:0xf
    v_add_f32_dpp v244, v244, v244 quad_perm:[1,0,3,2] row_mask:0xf bank_mask:0xf
    v_add_f32_dpp v245, v245, v245 quad_perm:[1,0,3,2] row_mask:0xf bank_mask:0xf
    v_add_f32_dpp v246, v246, v246 quad_perm:[1,0,3,2] row_mask:0xf bank_mask:0xf
    v_add_f32_dpp v240, v240, v240 quad_perm:[2,3,0,1] row_mask:0xf bank_mask:0xf
    v_add_f32_dpp v241, v241, v241 quad_perm:[2,3,0,1] row_mask:0xf bank_mask:0xf
    v_add_f32_dpp v242, v242, v242 quad_perm:[2,3,0,1] row_mask:0xf bank_mask:0xf
    v_add_f32_dpp v244, v244, v244 quad_perm:[2,3,0,1] row_mask:0xf bank_mask:0xf
    v_add_f32_dpp v245, v245, v245 quad_perm:[2,3,0,1] row_mask:0xf bank_mask:0xf
    v_add_f32_dpp v246, v246, v246 quad_perm:[2,3,0,1] row_mask:0xf bank_mask:0xf
    v_add_f32_dpp v240, v240, v240 row_half_mirror row_mask:0xf bank_mask:0xf
    v_add_f32_dpp v241, v241, v241 row_half_mirror row_mask:0xf bank_mask:0xf
    v_add_f32_dpp v242, v242, v242 row_half_mirror row_mask:0xf bank_mask:0xf
    v_add_f32_dpp v244, v244, v244 row_half_mirror row_mask:0xf bank_mask:0xf
    v_add_f32_dpp v245, v245, v245 row_half_mirror row_mask:0xf bank_mask:0xf
    v_add_f32_dpp v246, v246, v246 row_half_mirror row_mask:0xf bank_mask:0xf
    s_mul_i32 s32, s49, 96
    s_add_u32 s32, s32, 24576
    v_mul_u32_u24 v38, 6, v3
    v_add_u32 v38, s32, v38
    v_cvt_pk_bf16_f32 v32, v240, v241
    v_cvt_pk_bf16_f32 v33, v242, v242
    v_cvt_pk_bf16_f32 v34, v244, v245
    v_cvt_pk_bf16_f32 v35, v246, v246
    s_mov_b32 exec_lo, 0x01010101
    s_mov_b32 exec_hi, 0x01010101
    ds_write_b16 v38, v32 offset:0
    ds_write_b16_d16_hi v38, v32 offset:2
    ds_write_b16 v38, v33 offset:4
    ds_write_b16 v38, v34 offset:48
    ds_write_b16_d16_hi v38, v34 offset:50
    ds_write_b16 v38, v35 offset:52
    s_mov_b64 exec, -1
    s_waitcnt lgkmcnt(0)
    v_mov_b32 v46, 33284
    v_mov_b32 v47, 1
    s_mov_b64 exec, 1
    ds_add_u32 v46, v47
    s_mov_b64 exec, -1
    v_and_b32 v32, 3, v3
    v_cmp_eq_u32 s[38:39], 1, v32
    v_cmp_eq_u32 s[40:41], 2, v32
    v_cmp_eq_u32 s[42:43], 3, v32
    s_nop 0
    v_cndmask_b32 v208, v208, v209, s[38:39]
    v_cndmask_b32 v208, v208, v210, s[40:41]
    v_cndmask_b32 v208, v208, v211, s[42:43]
    v_cndmask_b32 v212, v212, v213, s[38:39]
    v_cndmask_b32 v212, v212, v214, s[40:41]
    v_cndmask_b32 v212, v212, v215, s[42:43]
    v_cndmask_b32 v216, v216, v217, s[38:39]
    v_cndmask_b32 v216, v216, v218, s[40:41]
    v_cndmask_b32 v216, v216, v219, s[42:43]
    v_cndmask_b32 v220, v220, v221, s[38:39]
    v_cndmask_b32 v220, v220, v222, s[40:41]
    v_cndmask_b32 v220, v220, v223, s[42:43]
    v_and_b32 v208, 0xffffff00, v208
    v_and_b32 v212, 0xffffff00, v212
    v_and_b32 v216, 0xffffff00, v216
    v_and_b32 v220, 0xffffff00, v220
    v_add_f32_dpp v208, v208, v208 quad_perm:[1,0,3,2] row_mask:0xf bank_mask:0xf
    v_add_f32_dpp v212, v212, v212 quad_perm:[1,0,3,2] row_mask:0xf bank_mask:0xf
    v_add_f32_dpp v216, v216, v216 quad_perm:[1,0,3,2] row_mask:0xf bank_mask:0xf
    v_add_f32_dpp v220, v220, v220 quad_perm:[1,0,3,2] row_mask:0xf bank_mask:0xf
    v_add_f32_dpp v208, v208, v208 quad_perm:[2,3,0,1] row_mask:0xf bank_mask:0xf
    v_add_f32_dpp v212, v212, v212 quad_perm:[2,3,0,1] row_mask:0xf bank_mask:0xf
    v_add_f32_dpp v216, v216, v216 quad_perm:[2,3,0,1] row_mask:0xf bank_mask:0xf
    v_add_f32_dpp v220, v220, v220 quad_perm:[2,3,0,1] row_mask:0xf bank_mask:0xf
    v_add_f32_dpp v208, v208, v208 row_half_mirror row_mask:0xf bank_mask:0xf
    v_add_f32_dpp v212, v212, v212 row_half_mirror row_mask:0xf bank_mask:0xf
    v_add_f32_dpp v216, v216, v216 row_half_mirror row_mask:0xf bank_mask:0xf
    v_add_f32_dpp v220, v220, v220 row_half_mirror row_mask:0xf bank_mask:0xf
    v_cvt_pk_bf16_f32 v208, v208, v208
    v_and_b32 v208, 0xffff0000, v208
    v_cvt_pk_bf16_f32 v216, v216, v216
    v_and_b32 v216, 0xffff0000, v216
    v_mul_f32 v35, 0xbfb8aa3b, v208
    v_exp_f32 v35, v35
    s_nop 0
    v_add_f32 v35, 1.0, v35
    v_rcp_f32 v35, v35
    s_nop 0
    v_mul_f32 v208, v208, v35
    v_cvt_pk_bf16_f32 v208, v208, v208
    v_and_b32 v208, 0xffff0000, v208
    v_mul_f32 v208, v208, v216
    v_cvt_pk_bf16_f32 v212, v212, v212
    v_and_b32 v212, 0xffff0000, v212
    v_cvt_pk_bf16_f32 v220, v220, v220
    v_and_b32 v220, 0xffff0000, v220
    v_mul_f32 v35, 0xbfb8aa3b, v212
    v_exp_f32 v35, v35
    s_nop 0
    v_add_f32 v35, 1.0, v35
    v_rcp_f32 v35, v35
    s_nop 0
    v_mul_f32 v212, v212, v35
    v_cvt_pk_bf16_f32 v212, v212, v212
    v_and_b32 v212, 0xffff0000, v212
    v_mul_f32 v212, v212, v220
    v_cvt_pk_bf16_f32 v39, v208, v208
    v_and_b32 v36, v39, v8
    v_and_b32 v37, v39, v9
    v_and_b32 v38, v39, v10
    v_and_b32 v39, v39, v11
    v_cvt_pk_bf16_f32 v43, v212, v212
    v_and_b32 v40, v43, v8
    v_and_b32 v41, v43, v9
    v_and_b32 v42, v43, v10
    v_and_b32 v43, v43, v11
    s_nop 1
    v_mfma_f32_16x16x32_bf16 v[228:231], v[36:39], v[232:235], 0
    v_mfma_f32_16x16x32_bf16 v[228:231], v[40:43], v[236:239], v[228:231]
    v_lshrrev_b32 v44, 5, v1
    s_lshl_b32 s32, s49, 1
    v_add_u32 v44, s32, v44
    v_mul_u32_u24 v44, 256, v44
    v_add_u32 v44, v44, v5
    v_add_u32 v44, 25088, v44
    s_nop 4
    s_mov_b32 exec_lo, 0x00ff00ff
    s_mov_b32 exec_hi, 0xff00ff00
    ds_write_b128 v44, v[228:231]
    s_mov_b64 exec, -1
    s_waitcnt lgkmcnt(0)
    v_mov_b32 v46, 33288
    v_mov_b32 v47, 1
    s_mov_b64 exec, 1
    ds_add_u32 v46, v47
    s_mov_b64 exec, -1
    v_mov_b32 v46, 33284
Lcw_20:
    ds_read_b32 v47, v46
    s_waitcnt lgkmcnt(0)
    v_readfirstlane_b32 s32, v47
    s_add_u32 s44, s44, 1
    s_cmp_ge_u32 s32, 4
    s_cbranch_scc1 Lcok_21
    s_cmp_gt_u32 s44, 4000000
    s_cbranch_scc1 Lcok_21
    s_sleep 1
    s_branch Lcw_20
Lcok_21:
    v_lshlrev_b32 v32, 4, v4
    ds_read_b128 v[12:15], v32 offset:24576
    ds_read_b128 v[16:19], v32 offset:24704
    ds_read_b128 v[20:23], v32 offset:24832
    s_waitcnt lgkmcnt(0)
    s_waitcnt vmcnt(28)
    v_dot2_f32_bf16 v24, v48, v12, 0
    v_dot2_f32_bf16 v25, v60, v12, 0
    v_dot2_f32_bf16 v26, v72, v12, 0
    v_dot2_f32_bf16 v27, v84, v12, 0
    v_dot2_f32_bf16 v24, v49, v13, v24
    v_dot2_f32_bf16 v25, v61, v13, v25
    v_dot2_f32_bf16 v26, v73, v13, v26
    v_dot2_f32_bf16 v27, v85, v13, v27
    v_dot2_f32_bf16 v24, v50, v14, v24
    v_dot2_f32_bf16 v25, v62, v14, v25
    v_dot2_f32_bf16 v26, v74, v14, v26
    v_dot2_f32_bf16 v27, v86, v14, v27
    v_dot2_f32_bf16 v24, v51, v15, v24
    v_dot2_f32_bf16 v25, v63, v15, v25
    v_dot2_f32_bf16 v26, v75, v15, v26
    v_dot2_f32_bf16 v27, v87, v15, v27
    v_dot2_f32_bf16 v24, v52, v16, v24
    v_dot2_f32_bf16 v25, v64, v16, v25
    v_dot2_f32_bf16 v26, v76, v16, v26
    v_dot2_f32_bf16 v27, v88, v16, v27
    v_dot2_f32_bf16 v24, v53, v17, v24
    v_dot2_f32_bf16 v25, v65, v17, v25
    v_dot2_f32_bf16 v26, v77, v17, v26
    v_dot2_f32_bf16 v27, v89, v17, v27
    v_dot2_f32_bf16 v24, v54, v18, v24
    v_dot2_f32_bf16 v25, v66, v18, v25
    v_dot2_f32_bf16 v26, v78, v18, v26
    v_dot2_f32_bf16 v27, v90, v18, v27
    v_dot2_f32_bf16 v24, v55, v19, v24
    v_dot2_f32_bf16 v25, v67, v19, v25
    v_dot2_f32_bf16 v26, v79, v19, v26
    v_dot2_f32_bf16 v27, v91, v19, v27
    v_dot2_f32_bf16 v24, v56, v20, v24
    v_dot2_f32_bf16 v25, v68, v20, v25
    v_dot2_f32_bf16 v26, v80, v20, v26
    v_dot2_f32_bf16 v27, v92, v20, v27
    v_dot2_f32_bf16 v24, v57, v21, v24
    v_dot2_f32_bf16 v25, v69, v21, v25
    v_dot2_f32_bf16 v26, v81, v21, v26
    v_dot2_f32_bf16 v27, v93, v21, v27
    v_dot2_f32_bf16 v24, v58, v22, v24
    v_dot2_f32_bf16 v25, v70, v22, v25
    v_dot2_f32_bf16 v26, v82, v22, v26
    v_dot2_f32_bf16 v27, v94, v22, v27
    v_dot2_f32_bf16 v24, v59, v23, v24
    v_dot2_f32_bf16 v25, v71, v23, v25
    v_dot2_f32_bf16 v26, v83, v23, v26
    v_dot2_f32_bf16 v27, v95, v23, v27
    global_load_dwordx4 v[184:187], v2, s[8:9] offset:3200 nt
    global_load_dwordx4 v[188:191], v2, s[8:9] offset:3328 nt
    s_waitcnt vmcnt(18)
    v_dot2_f32_bf16 v28, v96, v12, 0
    v_dot2_f32_bf16 v29, v108, v12, 0
    v_dot2_f32_bf16 v30, v120, v12, 0
    v_dot2_f32_bf16 v31, v132, v12, 0
    v_dot2_f32_bf16 v28, v97, v13, v28
    v_dot2_f32_bf16 v29, v109, v13, v29
    v_dot2_f32_bf16 v30, v121, v13, v30
    v_dot2_f32_bf16 v31, v133, v13, v31
    v_dot2_f32_bf16 v28, v98, v14, v28
    v_dot2_f32_bf16 v29, v110, v14, v29
    v_dot2_f32_bf16 v30, v122, v14, v30
    v_dot2_f32_bf16 v31, v134, v14, v31
    v_dot2_f32_bf16 v28, v99, v15, v28
    v_dot2_f32_bf16 v29, v111, v15, v29
    v_dot2_f32_bf16 v30, v123, v15, v30
    v_dot2_f32_bf16 v31, v135, v15, v31
    v_dot2_f32_bf16 v28, v100, v16, v28
    v_dot2_f32_bf16 v29, v112, v16, v29
    v_dot2_f32_bf16 v30, v124, v16, v30
    v_dot2_f32_bf16 v31, v136, v16, v31
    v_dot2_f32_bf16 v28, v101, v17, v28
    v_dot2_f32_bf16 v29, v113, v17, v29
    v_dot2_f32_bf16 v30, v125, v17, v30
    v_dot2_f32_bf16 v31, v137, v17, v31
    v_dot2_f32_bf16 v28, v102, v18, v28
    v_dot2_f32_bf16 v29, v114, v18, v29
    v_dot2_f32_bf16 v30, v126, v18, v30
    v_dot2_f32_bf16 v31, v138, v18, v31
    v_dot2_f32_bf16 v28, v103, v19, v28
    v_dot2_f32_bf16 v29, v115, v19, v29
    v_dot2_f32_bf16 v30, v127, v19, v30
    v_dot2_f32_bf16 v31, v139, v19, v31
    v_dot2_f32_bf16 v28, v104, v20, v28
    v_dot2_f32_bf16 v29, v116, v20, v29
    v_dot2_f32_bf16 v30, v128, v20, v30
    v_dot2_f32_bf16 v31, v140, v20, v31
    v_dot2_f32_bf16 v28, v105, v21, v28
    v_dot2_f32_bf16 v29, v117, v21, v29
    v_dot2_f32_bf16 v30, v129, v21, v30
    v_dot2_f32_bf16 v31, v141, v21, v31
    v_dot2_f32_bf16 v28, v106, v22, v28
    v_dot2_f32_bf16 v29, v118, v22, v29
    v_dot2_f32_bf16 v30, v130, v22, v30
    v_dot2_f32_bf16 v31, v142, v22, v31
    v_dot2_f32_bf16 v28, v107, v23, v28
    v_dot2_f32_bf16 v29, v119, v23, v29
    v_dot2_f32_bf16 v30, v131, v23, v30
    v_dot2_f32_bf16 v31, v143, v23, v31
    s_add_u32 s8, s8, 6144
    s_addc_u32 s9, s9, 0
    global_load_dwordx4 v[192:195], v2, s[8:9] offset:0 nt
    global_load_dwordx4 v[196:199], v2, s[8:9] offset:128 nt
    s_nop 2
    v_add_f32_dpp v24, v24, v24 quad_perm:[1,0,3,2] row_mask:0xf bank_mask:0xf
    v_add_f32_dpp v25, v25, v25 quad_perm:[1,0,3,2] row_mask:0xf bank_mask:0xf
    v_add_f32_dpp v26, v26, v26 quad_perm:[1,0,3,2] row_mask:0xf bank_mask:0xf
    v_add_f32_dpp v27, v27, v27 quad_perm:[1,0,3,2] row_mask:0xf bank_mask:0xf
    v_add_f32_dpp v28, v28, v28 quad_perm:[1,0,3,2] row_mask:0xf bank_mask:0xf
    v_add_f32_dpp v29, v29, v29 quad_perm:[1,0,3,2] row_mask:0xf bank_mask:0xf
    v_add_f32_dpp v30, v30, v30 quad_perm:[1,0,3,2] row_mask:0xf bank_mask:0xf
    v_add_f32_dpp v31, v31, v31 quad_perm:[1,0,3,2] row_mask:0xf bank_mask:0xf
    v_add_f32_dpp v24, v24, v24 quad_perm:[2,3,0,1] row_mask:0xf bank_mask:0xf
    v_add_f32_dpp v25, v25, v25 quad_perm:[2,3,0,1] row_mask:0xf bank_mask:0xf
    v_add_f32_dpp v26, v26, v26 quad_perm:[2,3,0,1] row_mask:0xf bank_mask:0xf
    v_add_f32_dpp v27, v27, v27 quad_perm:[2,3,0,1] row_mask:0xf bank_mask:0xf
    v_add_f32_dpp v28, v28, v28 quad_perm:[2,3,0,1] row_mask:0xf bank_mask:0xf
    v_add_f32_dpp v29, v29, v29 quad_perm:[2,3,0,1] row_mask:0xf bank_mask:0xf
    v_add_f32_dpp v30, v30, v30 quad_perm:[2,3,0,1] row_mask:0xf bank_mask:0xf
    v_add_f32_dpp v31, v31, v31 quad_perm:[2,3,0,1] row_mask:0xf bank_mask:0xf
    v_add_f32_dpp v24, v24, v24 row_half_mirror row_mask:0xf bank_mask:0xf
    v_add_f32_dpp v25, v25, v25 row_half_mirror row_mask:0xf bank_mask:0xf
    v_add_f32_dpp v26, v26, v26 row_half_mirror row_mask:0xf bank_mask:0xf
    v_add_f32_dpp v27, v27, v27 row_half_mirror row_mask:0xf bank_mask:0xf
    v_add_f32_dpp v28, v28, v28 row_half_mirror row_mask:0xf bank_mask:0xf
    v_add_f32_dpp v29, v29, v29 row_half_mirror row_mask:0xf bank_mask:0xf
    v_add_f32_dpp v30, v30, v30 row_half_mirror row_mask:0xf bank_mask:0xf
    v_add_f32_dpp v31, v31, v31 row_half_mirror row_mask:0xf bank_mask:0xf
    s_mov_b32 s32, 0x3d93cd3a
    v_cvt_pk_bf16_f32 v32, v24, v25
    v_lshlrev_b32 v24, 16, v32
    v_and_b32 v25, 0xffff0000, v32
    v_mul_f32 v24, s32, v24
    v_mul_f32 v25, s32, v25
    v_cvt_pk_bf16_f32 v32, v24, v25
    v_lshlrev_b32 v24, 16, v32
    v_and_b32 v25, 0xffff0000, v32
    v_cvt_pk_bf16_f32 v32, v26, v27
    v_lshlrev_b32 v26, 16, v32
    v_and_b32 v27, 0xffff0000, v32
    v_mul_f32 v26, s32, v26
    v_mul_f32 v27, s32, v27
    v_cvt_pk_bf16_f32 v32, v26, v27
    v_lshlrev_b32 v26, 16, v32
    v_and_b32 v27, 0xffff0000, v32
    v_cvt_pk_bf16_f32 v32, v28, v29
    v_lshlrev_b32 v28, 16, v32
    v_and_b32 v29, 0xffff0000, v32
    v_mul_f32 v28, s32, v28
    v_mul_f32 v29, s32, v29
    v_cvt_pk_bf16_f32 v32, v28, v29
    v_lshlrev_b32 v28, 16, v32
    v_and_b32 v29, 0xffff0000, v32
    v_cvt_pk_bf16_f32 v32, v30, v31
    v_lshlrev_b32 v30, 16, v32
    v_and_b32 v31, 0xffff0000, v32
    v_mul_f32 v30, s32, v30
    v_mul_f32 v31, s32, v31
    v_cvt_pk_bf16_f32 v32, v30, v31
    v_lshlrev_b32 v30, 16, v32
    v_and_b32 v31, 0xffff0000, v32
    v_max3_f32 v32, v24, v25, v26
    v_max3_f32 v33, v27, v28, v29
    v_max3_f32 v32, v32, v30, v31
    v_max_f32 v32, v32, v33
    s_nop 1
    v_max_f32_dpp v32, v32, v32 row_ror:8 row_mask:0xf bank_mask:0xf
    s_nop 1
    v_max_f32_dpp v32, v32, v32 row_bcast:15 row_mask:0xa bank_mask:0xf
    s_nop 1
    v_max_f32_dpp v32, v32, v32 row_bcast:31 row_mask:0xc bank_mask:0xf
    s_nop 1
    v_readlane_b32 s45, v32, 63
    s_nop 1
    s_mov_b32 s32, 0x3fb8aa3b
    v_subrev_f32 v24, s45, v24
    v_mul_f32 v24, s32, v24
    v_exp_f32 v24, v24
    v_subrev_f32 v25, s45, v25
    v_mul_f32 v25, s32, v25
    v_exp_f32 v25, v25
    v_subrev_f32 v26, s45, v26
    v_mul_f32 v26, s32, v26
    v_exp_f32 v26, v26
    v_subrev_f32 v27, s45, v27
    v_mul_f32 v27, s32, v27
    v_exp_f32 v27, v27
    v_subrev_f32 v28, s45, v28
    v_mul_f32 v28, s32, v28
    v_exp_f32 v28, v28
    v_subrev_f32 v29, s45, v29
    v_mul_f32 v29, s32, v29
    v_exp_f32 v29, v29
    v_subrev_f32 v30, s45, v30
    v_mul_f32 v30, s32, v30
    v_exp_f32 v30, v30
    v_subrev_f32 v31, s45, v31
    v_mul_f32 v31, s32, v31
    v_exp_f32 v31, v31
    s_nop 0
    v_add_f32 v32, v24, v25
    v_add_f32 v33, v26, v27
    v_add_f32 v34, v28, v29
    v_add_f32 v35, v30, v31
    v_add_f32 v32, v32, v33
    v_add_f32 v34, v34, v35
    v_add_f32 v32, v32, v34
    s_nop 1
    v_add_f32_dpp v32, v32, v32 row_ror:8 row_mask:0xf bank_mask:0xf
    s_nop 1
    v_add_f32_dpp v32, v32, v32 row_bcast:15 row_mask:0xa bank_mask:0xf
    s_nop 1
    v_add_f32_dpp v32, v32, v32 row_bcast:31 row_mask:0xc bank_mask:0xf
    s_nop 1
    v_readlane_b32 s46, v32, 63
    s_nop 1
    s_lshl_b32 s32, s3, 3
    s_add_u32 s32, s32, 33312
    v_mov_b32 v32, s32
    v_mov_b32 v34, s45
    v_mov_b32 v35, s46
    s_mov_b64 exec, 1
    ds_write_b64 v32, v[34:35]
    s_mov_b64 exec, -1
    s_waitcnt lgkmcnt(0)
    v_mov_b32 v46, 33292
    v_mov_b32 v47, 1
    s_mov_b64 exec, 1
    ds_add_u32 v46, v47
    s_mov_b64 exec, -1
    global_load_dwordx4 v[200:203], v2, s[8:9] offset:256 nt
    global_load_dwordx4 v[204:207], v2, s[8:9] offset:3072 nt
    global_load_dwordx4 v[208:211], v2, s[8:9] offset:3200 nt
    global_load_dwordx4 v[212:215], v2, s[8:9] offset:3328 nt
    s_add_u32 s8, s8, 6144
    s_addc_u32 s9, s9, 0
    global_load_dwordx4 v[216:219], v2, s[8:9] offset:0 nt
    global_load_dwordx4 v[220:223], v2, s[8:9] offset:128 nt
    global_load_dwordx4 v[224:227], v2, s[8:9] offset:256 nt
    global_load_dwordx4 v[228:231], v2, s[8:9] offset:3072 nt
    global_load_dwordx4 v[232:235], v2, s[8:9] offset:3200 nt
    global_load_dwordx4 v[236:239], v2, s[8:9] offset:3328 nt
    s_waitcnt lgkmcnt(0)
    v_mov_b32 v46, 33296
    v_mov_b32 v47, 1
    s_mov_b64 exec, 1
    ds_add_u32 v46, v47
    s_mov_b64 exec, -1
    v_mul_u32_u24 v253, 5120, v3
    v_lshl_add_u32 v253, v4, 4, v253
    global_load_dwordx4 v[96:99], v253, s[12:13] offset:0 nt
    global_load_dwordx4 v[100:103], v253, s[12:13] offset:1280 nt
    global_load_dwordx4 v[104:107], v253, s[12:13] offset:2560 nt
    global_load_dwordx4 v[108:111], v253, s[12:13] offset:3840 nt
    v_mov_b32 v46, 33292
Lcw_22:
    ds_read_b32 v47, v46
    s_waitcnt lgkmcnt(0)
    v_readfirstlane_b32 s32, v47
    s_add_u32 s44, s44, 1
    s_cmp_ge_u32 s32, 8
    s_cbranch_scc1 Lcok_23
    s_cmp_gt_u32 s44, 4000000
    s_cbranch_scc1 Lcok_23
    s_sleep 1
    s_branch Lcw_22
Lcok_23:
    v_lshlrev_b32 v32, 3, v4
    ds_read_b64 v[34:35], v32 offset:33312
    s_waitcnt lgkmcnt(0)
    v_mov_b32 v36, v34
    s_nop 1
    s_nop 1
    v_max_f32_dpp v36, v36, v36 quad_perm:[1,0,3,2] row_mask:0xf bank_mask:0xf
    s_nop 1
    v_max_f32_dpp v36, v36, v36 quad_perm:[2,3,0,1] row_mask:0xf bank_mask:0xf
    s_nop 1
    v_max_f32_dpp v36, v36, v36 row_half_mirror row_mask:0xf bank_mask:0xf
    s_mov_b32 s32, 0x3fb8aa3b
    v_sub_f32 v7, s45, v36
    v_mul_f32 v7, s32, v7
    v_exp_f32 v7, v7
    s_cmp_eq_u32 s3, 0
    s_cbranch_scc0 Lskip_ml_24
    v_sub_f32 v37, v34, v36
    v_mul_f32 v37, s32, v37
    v_exp_f32 v37, v37
    s_nop 0
    v_mul_f32 v37, v37, v35
    s_nop 1
    s_nop 1
    v_add_f32_dpp v37, v37, v37 quad_perm:[1,0,3,2] row_mask:0xf bank_mask:0xf
    s_nop 1
    v_add_f32_dpp v37, v37, v37 quad_perm:[2,3,0,1] row_mask:0xf bank_mask:0xf
    s_nop 1
    v_add_f32_dpp v37, v37, v37 row_half_mirror row_mask:0xf bank_mask:0xf
    v_mov_b32 v38, v36
    v_mov_b32 v39, v37
    v_bfi_b32 v36, v6, s95, v36
    v_bfi_b32 v37, v6, s95, v37
    v_bfi_b32 v38, v6, s95, v38
    v_bfi_b32 v39, v6, s95, v39
    s_lshl_b32 s33, s30, 3
    s_add_u32 s33, s33, s31
    s_mul_i32 s33, s33, 640
    v_mov_b32 v32, s33
    s_mov_b64 exec, 1
    global_store_dwordx4 v32, v[36:39], s[56:57] sc1
    s_mov_b64 exec, -1
Lskip_ml_24:
    v_mul_f32 v24, v7, v24
    v_mul_f32 v25, v7, v25
    v_mul_f32 v26, v7, v26
    v_mul_f32 v27, v7, v27
    v_mul_f32 v28, v7, v28
    v_mul_f32 v29, v7, v29
    v_mul_f32 v30, v7, v30
    v_mul_f32 v31, v7, v31
    v_cvt_pk_bf16_f32 v51, v24, v24
    v_and_b32 v48, v51, v8
    v_and_b32 v49, v51, v9
    v_and_b32 v50, v51, v10
    v_and_b32 v51, v51, v11
    v_cvt_pk_bf16_f32 v55, v25, v25
    v_and_b32 v52, v55, v8
    v_and_b32 v53, v55, v9
    v_and_b32 v54, v55, v10
    v_and_b32 v55, v55, v11
    v_cvt_pk_bf16_f32 v59, v26, v26
    v_and_b32 v56, v59, v8
    v_and_b32 v57, v59, v9
    v_and_b32 v58, v59, v10
    v_and_b32 v59, v59, v11
    v_cvt_pk_bf16_f32 v63, v27, v27
    v_and_b32 v60, v63, v8
    v_and_b32 v61, v63, v9
    v_and_b32 v62, v63, v10
    v_and_b32 v63, v63, v11
    v_cvt_pk_bf16_f32 v67, v28, v28
    v_and_b32 v64, v67, v8
    v_and_b32 v65, v67, v9
    v_and_b32 v66, v67, v10
    v_and_b32 v67, v67, v11
    v_cvt_pk_bf16_f32 v71, v29, v29
    v_and_b32 v68, v71, v8
    v_and_b32 v69, v71, v9
    v_and_b32 v70, v71, v10
    v_and_b32 v71, v71, v11
    v_cvt_pk_bf16_f32 v75, v30, v30
    v_and_b32 v72, v75, v8
    v_and_b32 v73, v75, v9
    v_and_b32 v74, v75, v10
    v_and_b32 v75, v75, v11
    v_cvt_pk_bf16_f32 v79, v31, v31
    v_and_b32 v76, v79, v8
    v_and_b32 v77, v79, v9
    v_and_b32 v78, v79, v10
    v_and_b32 v79, v79, v11
    s_waitcnt vmcnt(25)
    v_mfma_f32_16x16x32_bf16 v[80:83], v[48:51], v[144:147], 0
    v_mfma_f32_16x16x32_bf16 v[84:87], v[48:51], v[148:151], 0
    v_mfma_f32_16x16x32_bf16 v[88:91], v[48:51], v[152:155], 0
    s_waitcnt vmcnt(22)
    v_mfma_f32_16x16x32_bf16 v[80:83], v[52:55], v[156:159], v[80:83]
    v_mfma_f32_16x16x32_bf16 v[84:87], v[52:55], v[160:163], v[84:87]
    v_mfma_f32_16x16x32_bf16 v[88:91], v[52:55], v[164:167], v[88:91]
    s_waitcnt vmcnt(19)
    v_mfma_f32_16x16x32_bf16 v[80:83], v[56:59], v[168:171], v[80:83]
    v_mfma_f32_16x16x32_bf16 v[84:87], v[56:59], v[172:175], v[84:87]
    v_mfma_f32_16x16x32_bf16 v[88:91], v[56:59], v[176:179], v[88:91]
    s_waitcnt vmcnt(16)
    v_mfma_f32_16x16x32_bf16 v[80:83], v[60:63], v[180:183], v[80:83]
    v_mfma_f32_16x16x32_bf16 v[84:87], v[60:63], v[184:187], v[84:87]
    v_mfma_f32_16x16x32_bf16 v[88:91], v[60:63], v[188:191], v[88:91]
    s_waitcnt vmcnt(13)
    v_mfma_f32_16x16x32_bf16 v[80:83], v[64:67], v[192:195], v[80:83]
    v_mfma_f32_16x16x32_bf16 v[84:87], v[64:67], v[196:199], v[84:87]
    v_mfma_f32_16x16x32_bf16 v[88:91], v[64:67], v[200:203], v[88:91]
    s_waitcnt vmcnt(10)
    v_mfma_f32_16x16x32_bf16 v[80:83], v[68:71], v[204:207], v[80:83]
    v_mfma_f32_16x16x32_bf16 v[84:87], v[68:71], v[208:211], v[84:87]
    v_mfma_f32_16x16x32_bf16 v[88:91], v[68:71], v[212:215], v[88:91]
    s_waitcnt vmcnt(7)
    v_mfma_f32_16x16x32_bf16 v[80:83], v[72:75], v[216:219], v[80:83]
    v_mfma_f32_16x16x32_bf16 v[84:87], v[72:75], v[220:223], v[84:87]
    v_mfma_f32_16x16x32_bf16 v[88:91], v[72:75], v[224:227], v[88:91]
    s_waitcnt vmcnt(4)
    v_mfma_f32_16x16x32_bf16 v[80:83], v[76:79], v[228:231], v[80:83]
    v_mfma_f32_16x16x32_bf16 v[84:87], v[76:79], v[232:235], v[84:87]
    v_mfma_f32_16x16x32_bf16 v[88:91], v[76:79], v[236:239], v[88:91]
    v_lshrrev_b32 v32, 5, v1
    s_lshl_b32 s32, s3, 1
    v_add_u32 v32, s32, v32
    v_mul_u32_u24 v32, 768, v32
    v_add_u32 v32, v32, v5
    s_nop 3
    s_mov_b32 exec_lo, 0x00ff00ff
    s_mov_b32 exec_hi, 0xff00ff00
    ds_write_b128 v32, v[80:83] offset:0
    ds_write_b128 v32, v[84:87] offset:256
    ds_write_b128 v32, v[88:91] offset:512
    s_mov_b64 exec, -1
L_tail_n:
    s_lshl_b32 s32, s3, 7
    v_lshl_add_u32 v33, v3, 4, s32
    v_mul_u32_u24 v34, 1536, v4
    v_add_u32 v34, v33, v34
    s_lshl_b32 s32, s30, 3
    s_add_u32 s32, s32, s31
    s_mul_i32 s32, s32, 768
    v_add_u32 v35, s32, v33
    s_waitcnt lgkmcnt(0)
    s_barrier
    s_cmp_lt_u32 s3, 6
    s_cbranch_scc0 Lskip_o_25
    ds_read_b128 v[240:243], v34 offset:0
    ds_read_b128 v[244:247], v34 offset:768
    s_waitcnt lgkmcnt(0)
    v_pk_add_f32 v[240:241], v[240:241], v[244:245]
    v_pk_add_f32 v[242:243], v[242:243], v[246:247]
    s_nop 1
    v_add_f32_dpp v240, v240, v240 quad_perm:[1,0,3,2] row_mask:0xf bank_mask:0xf
    v_add_f32_dpp v241, v241, v241 quad_perm:[1,0,3,2] row_mask:0xf bank_mask:0xf
    v_add_f32_dpp v242, v242, v242 quad_perm:[1,0,3,2] row_mask:0xf bank_mask:0xf
    v_add_f32_dpp v243, v243, v243 quad_perm:[1,0,3,2] row_mask:0xf bank_mask:0xf
    v_add_f32_dpp v240, v240, v240 quad_perm:[2,3,0,1] row_mask:0xf bank_mask:0xf
    v_add_f32_dpp v241, v241, v241 quad_perm:[2,3,0,1] row_mask:0xf bank_mask:0xf
    v_add_f32_dpp v242, v242, v242 quad_perm:[2,3,0,1] row_mask:0xf bank_mask:0xf
    v_add_f32_dpp v243, v243, v243 quad_perm:[2,3,0,1] row_mask:0xf bank_mask:0xf
    v_add_f32_dpp v240, v240, v240 row_half_mirror row_mask:0xf bank_mask:0xf
    v_add_f32_dpp v241, v241, v241 row_half_mirror row_mask:0xf bank_mask:0xf
    v_add_f32_dpp v242, v242, v242 row_half_mirror row_mask:0xf bank_mask:0xf
    v_add_f32_dpp v243, v243, v243 row_half_mirror row_mask:0xf bank_mask:0xf
    v_bfi_b32 v240, v6, s95, v240
    v_bfi_b32 v241, v6, s95, v241
    v_bfi_b32 v242, v6, s95, v242
    v_bfi_b32 v243, v6, s95, v243
    s_mov_b32 exec_lo, 0x01010101
    s_mov_b32 exec_hi, 0x01010101
    global_store_dwordx4 v35, v[240:243], s[54:55] sc1
    s_mov_b64 exec, -1
Lskip_o_25:
    s_lshl_b32 s32, s28, 3
    s_add_u32 s32, s32, s3
    s_mul_i32 s33, s32, 171
    s_lshr_b32 s33, s33, 10
    s_mul_i32 s34, s33, 6
    s_sub_u32 s34, s32, s34
    s_lshl_b32 s35, s33, 3
    v_add_u32 v116, s35, v4
    v_mul_u32_u24 v116, 640, v116
    s_mul_i32 s33, s33, 6144
    s_lshl_b32 s34, s34, 7
    s_add_u32 s33, s33, s34
    v_mul_u32_u24 v117, 768, v4
    v_lshl_add_u32 v117, v3, 4, v117
    v_add_u32 v117, s33, v117
    global_load_dwordx4 v[120:123], v116, s[56:57] sc1
    global_load_dwordx4 v[112:115], v117, s[54:55] sc1
    v_lshrrev_b32 v41, 5, v1
    s_lshl_b32 s32, s3, 1
    v_add_u32 v41, s32, v41
    v_mul_u32_u24 v41, 256, v41
    v_add_u32 v41, v41, v5
    v_add_u32 v41, 29184, v41
    s_waitcnt vmcnt(1)
    v_perm_b32 v32, v121, v120, s92
    v_perm_b32 v32, v122, v32, s93
    v_perm_b32 v32, v123, v32, s94
    v_cmp_ne_u32 vcc, s59, v32
    s_cbranch_vccz Lok_ml_26
Lre_ml_27:
    s_add_u32 s44, s44, 1
    s_cmp_gt_u32 s44, 200000
    s_cbranch_scc1 Lok_ml_26
    s_sleep 1
    s_mov_b64 exec, vcc
    global_load_dwordx4 v[120:123], v116, s[56:57] sc1
    s_mov_b64 exec, -1
    s_waitcnt vmcnt(0)
    v_perm_b32 v32, v121, v120, s92
    v_perm_b32 v32, v122, v32, s93
    v_perm_b32 v32, v123, v32, s94
    v_cmp_ne_u32 vcc, s59, v32
    s_cbranch_vccnz Lre_ml_27
Lok_ml_26:
    v_and_b32 v120, 0xffffff00, v120
    v_and_b32 v121, 0xffffff00, v121
    v_mov_b32 v32, v120
    s_nop 1
    s_nop 1
    v_max_f32_dpp v32, v32, v32 quad_perm:[1,0,3,2] row_mask:0xf bank_mask:0xf
    s_nop 1
    v_max_f32_dpp v32, v32, v32 quad_perm:[2,3,0,1] row_mask:0xf bank_mask:0xf
    s_nop 1
    v_max_f32_dpp v32, v32, v32 row_half_mirror row_mask:0xf bank_mask:0xf
    s_mov_b32 s32, 0x3fb8aa3b
    v_sub_f32 v32, v120, v32
    v_mul_f32 v32, s32, v32
    v_exp_f32 v32, v32
    s_nop 0
    v_mul_f32 v33, v32, v121
    s_nop 1
    s_nop 1
    v_add_f32_dpp v33, v33, v33 quad_perm:[1,0,3,2] row_mask:0xf bank_mask:0xf
    s_nop 1
    v_add_f32_dpp v33, v33, v33 quad_perm:[2,3,0,1] row_mask:0xf bank_mask:0xf
    s_nop 1
    v_add_f32_dpp v33, v33, v33 row_half_mirror row_mask:0xf bank_mask:0xf
    v_rcp_f32 v33, v33
    s_nop 0
    v_mul_f32 v34, v32, v33
    s_waitcnt vmcnt(0)
    v_perm_b32 v32, v113, v112, s92
    v_perm_b32 v32, v114, v32, s93
    v_perm_b32 v32, v115, v32, s94
    v_cmp_ne_u32 vcc, s59, v32
    s_cbranch_vccz Lok_o_28
    s_mov_b64 exec, vcc
    global_load_dwordx4 v[112:115], v117, s[54:55] sc1
    s_mov_b64 exec, -1
    s_sleep 2
Llp_o_29:
    s_add_u32 s44, s44, 1
    s_cmp_gt_u32 s44, 400000
    s_cbranch_scc1 Lok_o_28
    s_mov_b64 exec, vcc
    global_load_dwordx4 v[112:115], v117, s[54:55] sc1
    s_mov_b64 exec, -1
    s_waitcnt vmcnt(1)
    v_perm_b32 v32, v113, v112, s92
    v_perm_b32 v32, v114, v32, s93
    v_perm_b32 v32, v115, v32, s94
    v_cmp_ne_u32 vcc, s59, v32
    s_cbranch_vccnz Llp_o_29
Lok_o_28:
    v_and_b32 v244, 0xffffff00, v112
    v_and_b32 v245, 0xffffff00, v113
    v_and_b32 v246, 0xffffff00, v114
    v_and_b32 v247, 0xffffff00, v115
    v_mul_f32 v244, v34, v244
    v_mul_f32 v245, v34, v245
    v_mul_f32 v246, v34, v246
    v_mul_f32 v247, v34, v247
    v_add_f32_dpp v244, v244, v244 quad_perm:[1,0,3,2] row_mask:0xf bank_mask:0xf
    v_add_f32_dpp v245, v245, v245 quad_perm:[1,0,3,2] row_mask:0xf bank_mask:0xf
    v_add_f32_dpp v246, v246, v246 quad_perm:[1,0,3,2] row_mask:0xf bank_mask:0xf
    v_add_f32_dpp v247, v247, v247 quad_perm:[1,0,3,2] row_mask:0xf bank_mask:0xf
    v_add_f32_dpp v244, v244, v244 quad_perm:[2,3,0,1] row_mask:0xf bank_mask:0xf
    v_add_f32_dpp v245, v245, v245 quad_perm:[2,3,0,1] row_mask:0xf bank_mask:0xf
    v_add_f32_dpp v246, v246, v246 quad_perm:[2,3,0,1] row_mask:0xf bank_mask:0xf
    v_add_f32_dpp v247, v247, v247 quad_perm:[2,3,0,1] row_mask:0xf bank_mask:0xf
    v_add_f32_dpp v244, v244, v244 row_half_mirror row_mask:0xf bank_mask:0xf
    v_add_f32_dpp v245, v245, v245 row_half_mirror row_mask:0xf bank_mask:0xf
    v_add_f32_dpp v246, v246, v246 row_half_mirror row_mask:0xf bank_mask:0xf
    v_add_f32_dpp v247, v247, v247 row_half_mirror row_mask:0xf bank_mask:0xf
    v_cvt_pk_bf16_f32 v51, v244, v244
    v_and_b32 v48, v51, v8
    v_and_b32 v49, v51, v9
    v_and_b32 v50, v51, v10
    v_and_b32 v51, v51, v11
    v_cvt_pk_bf16_f32 v55, v245, v245
    v_and_b32 v52, v55, v8
    v_and_b32 v53, v55, v9
    v_and_b32 v54, v55, v10
    v_and_b32 v55, v55, v11
    v_cvt_pk_bf16_f32 v59, v246, v246
    v_and_b32 v56, v59, v8
    v_and_b32 v57, v59, v9
    v_and_b32 v58, v59, v10
    v_and_b32 v59, v59, v11
    v_cvt_pk_bf16_f32 v63, v247, v247
    v_and_b32 v60, v63, v8
    v_and_b32 v61, v63, v9
    v_and_b32 v62, v63, v10
    v_and_b32 v63, v63, v11
    s_nop 1
    v_mfma_f32_16x16x32_bf16 v[92:95], v[48:51], v[96:99], 0
    v_mfma_f32_16x16x32_bf16 v[92:95], v[52:55], v[100:103], v[92:95]
    v_mfma_f32_16x16x32_bf16 v[92:95], v[56:59], v[104:107], v[92:95]
    v_mfma_f32_16x16x32_bf16 v[92:95], v[60:63], v[108:111], v[92:95]
    s_nop 7
    s_mov_b32 exec_lo, 0x00ff00ff
    s_mov_b32 exec_hi, 0xff00ff00
    ds_write_b128 v41, v[92:95]
    s_mov_b64 exec, -1
    s_waitcnt lgkmcnt(0)
    s_barrier
    s_cmp_eq_u32 s3, 0
    s_cbranch_scc0 Lskip_s_30
    s_mul_i32 s35, s15, 640
    s_add_u32 s35, s35, 128
    v_and_b32 v32, 3, v1
    v_lshlrev_b32 v32, 10, v32
    v_lshrrev_b32 v33, 2, v1
    v_lshl_add_u32 v32, v33, 4, v32
    ds_read_b128 v[240:243], v32 offset:29184
    ds_read_b128 v[244:247], v32 offset:29440
    ds_read_b128 v[248:251], v32 offset:29696
    ds_read_b128 v[252:255], v32 offset:29952
    v_lshlrev_b32 v33, 4, v33
    v_add_u32 v33, s35, v33
    s_waitcnt lgkmcnt(0)
    v_pk_add_f32 v[240:241], v[240:241], v[244:245]
    v_pk_add_f32 v[248:249], v[248:249], v[252:253]
    v_pk_add_f32 v[242:243], v[242:243], v[246:247]
    v_pk_add_f32 v[250:251], v[250:251], v[254:255]
    v_pk_add_f32 v[240:241], v[240:241], v[248:249]
    v_pk_add_f32 v[242:243], v[242:243], v[250:251]
    s_nop 0
    v_add_f32_dpp v240, v240, v240 quad_perm:[1,0,3,2] row_mask:0xf bank_mask:0xf
    v_add_f32_dpp v241, v241, v241 quad_perm:[1,0,3,2] row_mask:0xf bank_mask:0xf
    v_add_f32_dpp v242, v242, v242 quad_perm:[1,0,3,2] row_mask:0xf bank_mask:0xf
    v_add_f32_dpp v243, v243, v243 quad_perm:[1,0,3,2] row_mask:0xf bank_mask:0xf
    v_add_f32_dpp v240, v240, v240 quad_perm:[2,3,0,1] row_mask:0xf bank_mask:0xf
    v_add_f32_dpp v241, v241, v241 quad_perm:[2,3,0,1] row_mask:0xf bank_mask:0xf
    v_add_f32_dpp v242, v242, v242 quad_perm:[2,3,0,1] row_mask:0xf bank_mask:0xf
    v_add_f32_dpp v243, v243, v243 quad_perm:[2,3,0,1] row_mask:0xf bank_mask:0xf
    v_bfi_b32 v240, v6, s95, v240
    v_bfi_b32 v241, v6, s95, v241
    v_bfi_b32 v242, v6, s95, v242
    v_bfi_b32 v243, v6, s95, v243
    s_mov_b32 exec_lo, 0x11111111
    s_mov_b32 exec_hi, 0x11111111
    global_store_dwordx4 v33, v[240:243], s[56:57] sc1
    s_mov_b64 exec, -1
Lskip_s_30:
    s_endpgm
L_light:
    s_cmp_ge_u32 s3, 4
    s_cbranch_scc1 L_worker_l
    v_mov_b32 v40, 33280
    v_mov_b32 v42, 0
    v_mov_b32 v43, 0
    v_mov_b32 v44, 0
    v_mov_b32 v45, 0
    s_mov_b64 exec, 1
    ds_write_b128 v40, v[42:45]
    ds_write_b128 v40, v[42:45] offset:16
    s_mov_b64 exec, -1
    s_waitcnt lgkmcnt(0)
    s_barrier
    s_load_dword s58, s[26:27], 0xf0000
    s_getpc_b64 s[32:33]
Lpc_31:
    s_sub_u32 s32, s32, Lpc_31-recurrent_scan__mha_block_cached__swiglu_ffn__decode_kernel
    s_subb_u32 s33, s33, 0
    s_lshr_b32 s34, s2, 3
    s_and_b32 s34, s34, 7
    s_lshl_b32 s34, s34, 2
    s_add_u32 s34, s34, s3
    s_lshl_b32 s34, s34, 10
    v_lshl_add_u32 v32, v1, 4, s34
    v_min_u32 v32, L_codeend-recurrent_scan__mha_block_cached__swiglu_ffn__decode_kernel-16, v32
    global_load_dwordx4 v[240:243], v32, s[32:33]
    s_waitcnt vmcnt(6)
    s_add_u32 s6, s6, 6144
    s_addc_u32 s7, s7, 0
    global_load_dwordx4 v[72:75], v2, s[6:7] offset:0 nt
    v_and_b32 v32, 1, v1
    v_lshlrev_b32 v32, 4, v32
    v_mov_b32 v33, 0xffff
    v_lshlrev_b32 v33, v32, v33
    v_bfe_u32 v34, v1, 1, 2
    v_cmp_eq_u32 s[36:37], 0, v34
    v_cmp_eq_u32 s[38:39], 1, v34
    v_cmp_eq_u32 s[40:41], 2, v34
    v_cmp_eq_u32 s[42:43], 3, v34
    s_nop 0
    v_cndmask_b32 v8, 0, v33, s[36:37]
    v_cndmask_b32 v9, 0, v33, s[38:39]
    v_cndmask_b32 v10, 0, v33, s[40:41]
    v_cndmask_b32 v11, 0, v33, s[42:43]
    v_bfe_u32 v32, v1, 4, 1
    v_lshlrev_b32 v32, 4, v32
    v_lshl_add_u32 v5, v4, 5, v32
    v_mov_b32 v6, 0xff
    s_mov_b32 s92, 0x0c0c0400
    s_mov_b32 s93, 0x0c040100
    s_mov_b32 s94, 0x04020100
    s_add_u32 s54, s26, 0x80000
    s_addc_u32 s55, s27, 0
    s_add_u32 s56, s26, 0xb0000
    s_addc_u32 s57, s27, 0
    s_waitcnt vmcnt(6)
    global_load_dwordx4 v[76:79], v2, s[6:7] offset:128 nt
    s_waitcnt vmcnt(6)
    global_load_dwordx4 v[80:83], v2, s[6:7] offset:256 nt
    s_waitcnt vmcnt(6)
    global_load_dwordx4 v[84:87], v2, s[6:7] offset:3072 nt
    s_waitcnt vmcnt(6)
    global_load_dwordx4 v[88:91], v2, s[6:7] offset:3200 nt
    s_waitcnt vmcnt(6)
    global_load_dwordx4 v[92:95], v2, s[6:7] offset:3328 nt
    s_waitcnt vmcnt(5)
    s_add_u32 s6, s6, 6144
    s_addc_u32 s7, s7, 0
    global_load_dwordx4 v[96:99], v2, s[6:7] offset:0 nt
    s_waitcnt vmcnt(5)
    global_load_dwordx4 v[100:103], v2, s[6:7] offset:128 nt
    s_waitcnt vmcnt(5)
    global_load_dwordx4 v[104:107], v2, s[6:7] offset:256 nt
    s_waitcnt vmcnt(5)
    global_load_dwordx4 v[108:111], v2, s[6:7] offset:3072 nt
    s_waitcnt vmcnt(5)
    global_load_dwordx4 v[112:115], v2, s[6:7] offset:3200 nt
    s_waitcnt vmcnt(5)
    global_load_dwordx4 v[116:119], v2, s[6:7] offset:3328 nt
    s_waitcnt vmcnt(5)
    s_add_u32 s6, s6, 6144
    s_addc_u32 s7, s7, 0
    global_load_dwordx4 v[120:123], v2, s[6:7] offset:0 nt
    s_waitcnt vmcnt(5)
    global_load_dwordx4 v[124:127], v2, s[6:7] offset:128 nt
    s_waitcnt vmcnt(5)
    global_load_dwordx4 v[128:131], v2, s[6:7] offset:256 nt
    s_waitcnt vmcnt(5)
    global_load_dwordx4 v[132:135], v2, s[6:7] offset:3072 nt
    s_waitcnt vmcnt(5)
    global_load_dwordx4 v[136:139], v2, s[6:7] offset:3200 nt
    s_waitcnt vmcnt(5)
    global_load_dwordx4 v[140:143], v2, s[6:7] offset:3328 nt
    s_waitcnt vmcnt(5)
    global_load_dwordx4 v[144:147], v2, s[8:9] offset:0 nt
    s_waitcnt vmcnt(5)
    global_load_dwordx4 v[148:151], v2, s[8:9] offset:128 nt
    s_waitcnt vmcnt(5)
    global_load_dwordx4 v[152:155], v2, s[8:9] offset:256 nt
    s_waitcnt vmcnt(5)
    global_load_dwordx4 v[156:159], v2, s[8:9] offset:3072 nt
    s_waitcnt vmcnt(5)
    global_load_dwordx4 v[160:163], v2, s[8:9] offset:3200 nt
    s_waitcnt vmcnt(5)
    global_load_dwordx4 v[164:167], v2, s[8:9] offset:3328 nt
    s_waitcnt vmcnt(5)
    s_add_u32 s8, s8, 6144
    s_addc_u32 s9, s9, 0
    global_load_dwordx4 v[168:171], v2, s[8:9] offset:0 nt
    s_waitcnt vmcnt(5)
    global_load_dwordx4 v[172:175], v2, s[8:9] offset:128 nt
    s_waitcnt vmcnt(5)
    global_load_dwordx4 v[176:179], v2, s[8:9] offset:256 nt
    s_waitcnt vmcnt(5)
    global_load_dwordx4 v[180:183], v2, s[8:9] offset:3072 nt
    s_waitcnt vmcnt(5)
    global_load_dwordx4 v[184:187], v2, s[8:9] offset:3200 nt
    s_waitcnt vmcnt(5)
    global_load_dwordx4 v[188:191], v2, s[8:9] offset:3328 nt
    s_waitcnt vmcnt(5)
    s_add_u32 s8, s8, 6144
    s_addc_u32 s9, s9, 0
    global_load_dwordx4 v[192:195], v2, s[8:9] offset:0 nt
    s_waitcnt vmcnt(5)
    global_load_dwordx4 v[196:199], v2, s[8:9] offset:128 nt
    s_waitcnt vmcnt(5)
    global_load_dwordx4 v[200:203], v2, s[8:9] offset:256 nt
    s_waitcnt vmcnt(5)
    global_load_dwordx4 v[204:207], v2, s[8:9] offset:3072 nt
    s_waitcnt vmcnt(5)
    global_load_dwordx4 v[208:211], v2, s[8:9] offset:3200 nt
    s_waitcnt vmcnt(5)
    global_load_dwordx4 v[212:215], v2, s[8:9] offset:3328 nt
    s_waitcnt vmcnt(5)
    s_add_u32 s8, s8, 6144
    s_addc_u32 s9, s9, 0
    global_load_dwordx4 v[216:219], v2, s[8:9] offset:0 nt
    s_waitcnt vmcnt(5)
    global_load_dwordx4 v[220:223], v2, s[8:9] offset:128 nt
    s_waitcnt vmcnt(5)
    global_load_dwordx4 v[224:227], v2, s[8:9] offset:256 nt
    s_waitcnt vmcnt(5)
    global_load_dwordx4 v[228:231], v2, s[8:9] offset:3072 nt
    s_waitcnt vmcnt(5)
    global_load_dwordx4 v[232:235], v2, s[8:9] offset:3200 nt
    s_waitcnt vmcnt(5)
    global_load_dwordx4 v[236:239], v2, s[8:9] offset:3328 nt
    s_waitcnt lgkmcnt(0)
    s_add_u32 s58, s58, 1
    s_and_b32 s95, s58, 0xff
    s_mul_i32 s59, s95, 0x01010101
    v_mov_b32 v46, 33284
Lcw_32:
    ds_read_b32 v47, v46
    s_waitcnt lgkmcnt(0)
    v_readfirstlane_b32 s32, v47
    s_add_u32 s44, s44, 1
    s_cmp_ge_u32 s32, 4
    s_cbranch_scc1 Lcok_33
    s_cmp_gt_u32 s44, 4000000
    s_cbranch_scc1 Lcok_33
    s_sleep 1
    s_branch Lcw_32
Lcok_33:
    v_lshlrev_b32 v32, 4, v4
    ds_read_b128 v[12:15], v32 offset:24576
    ds_read_b128 v[16:19], v32 offset:24704
    ds_read_b128 v[20:23], v32 offset:24832
    s_waitcnt lgkmcnt(0)
    s_waitcnt vmcnt(36)
    v_dot2_f32_bf16 v24, v48, v12, 0
    v_dot2_f32_bf16 v25, v60, v12, 0
    v_dot2_f32_bf16 v26, v72, v12, 0
    v_dot2_f32_bf16 v27, v84, v12, 0
    v_dot2_f32_bf16 v24, v49, v13, v24
    v_dot2_f32_bf16 v25, v61, v13, v25
    v_dot2_f32_bf16 v26, v73, v13, v26
    v_dot2_f32_bf16 v27, v85, v13, v27
    v_dot2_f32_bf16 v24, v50, v14, v24
    v_dot2_f32_bf16 v25, v62, v14, v25
    v_dot2_f32_bf16 v26, v74, v14, v26
    v_dot2_f32_bf16 v27, v86, v14, v27
    v_dot2_f32_bf16 v24, v51, v15, v24
    v_dot2_f32_bf16 v25, v63, v15, v25
    v_dot2_f32_bf16 v26, v75, v15, v26
    v_dot2_f32_bf16 v27, v87, v15, v27
    v_dot2_f32_bf16 v24, v52, v16, v24
    v_dot2_f32_bf16 v25, v64, v16, v25
    v_dot2_f32_bf16 v26, v76, v16, v26
    v_dot2_f32_bf16 v27, v88, v16, v27
    v_dot2_f32_bf16 v24, v53, v17, v24
    v_dot2_f32_bf16 v25, v65, v17, v25
    v_dot2_f32_bf16 v26, v77, v17, v26
    v_dot2_f32_bf16 v27, v89, v17, v27
    v_dot2_f32_bf16 v24, v54, v18, v24
    v_dot2_f32_bf16 v25, v66, v18, v25
    v_dot2_f32_bf16 v26, v78, v18, v26
    v_dot2_f32_bf16 v27, v90, v18, v27
    v_dot2_f32_bf16 v24, v55, v19, v24
    v_dot2_f32_bf16 v25, v67, v19, v25
    v_dot2_f32_bf16 v26, v79, v19, v26
    v_dot2_f32_bf16 v27, v91, v19, v27
    v_dot2_f32_bf16 v24, v56, v20, v24
    v_dot2_f32_bf16 v25, v68, v20, v25
    v_dot2_f32_bf16 v26, v80, v20, v26
    v_dot2_f32_bf16 v27, v92, v20, v27
    v_dot2_f32_bf16 v24, v57, v21, v24
    v_dot2_f32_bf16 v25, v69, v21, v25
    v_dot2_f32_bf16 v26, v81, v21, v26
    v_dot2_f32_bf16 v27, v93, v21, v27
    v_dot2_f32_bf16 v24, v58, v22, v24
    v_dot2_f32_bf16 v25, v70, v22, v25
    v_dot2_f32_bf16 v26, v82, v22, v26
    v_dot2_f32_bf16 v27, v94, v22, v27
    v_dot2_f32_bf16 v24, v59, v23, v24
    v_dot2_f32_bf16 v25, v71, v23, v25
    v_dot2_f32_bf16 v26, v83, v23, v26
    v_dot2_f32_bf16 v27, v95, v23, v27
    s_waitcnt vmcnt(24)
    v_dot2_f32_bf16 v28, v96, v12, 0
    v_dot2_f32_bf16 v29, v108, v12, 0
    v_dot2_f32_bf16 v30, v120, v12, 0
    v_dot2_f32_bf16 v31, v132, v12, 0
    v_dot2_f32_bf16 v28, v97, v13, v28
    v_dot2_f32_bf16 v29, v109, v13, v29
    v_dot2_f32_bf16 v30, v121, v13, v30
    v_dot2_f32_bf16 v31, v133, v13, v31
    v_dot2_f32_bf16 v28, v98, v14, v28
    v_dot2_f32_bf16 v29, v110, v14, v29
    v_dot2_f32_bf16 v30, v122, v14, v30
    v_dot2_f32_bf16 v31, v134, v14, v31
    v_dot2_f32_bf16 v28, v99, v15, v28
    v_dot2_f32_bf16 v29, v111, v15, v29
    v_dot2_f32_bf16 v30, v123, v15, v30
    v_dot2_f32_bf16 v31, v135, v15, v31
    v_dot2_f32_bf16 v28, v100, v16, v28
    v_dot2_f32_bf16 v29, v112, v16, v29
    v_dot2_f32_bf16 v30, v124, v16, v30
    v_dot2_f32_bf16 v31, v136, v16, v31
    v_dot2_f32_bf16 v28, v101, v17, v28
    v_dot2_f32_bf16 v29, v113, v17, v29
    v_dot2_f32_bf16 v30, v125, v17, v30
    v_dot2_f32_bf16 v31, v137, v17, v31
    v_dot2_f32_bf16 v28, v102, v18, v28
    v_dot2_f32_bf16 v29, v114, v18, v29
    v_dot2_f32_bf16 v30, v126, v18, v30
    v_dot2_f32_bf16 v31, v138, v18, v31
    v_dot2_f32_bf16 v28, v103, v19, v28
    v_dot2_f32_bf16 v29, v115, v19, v29
    v_dot2_f32_bf16 v30, v127, v19, v30
    v_dot2_f32_bf16 v31, v139, v19, v31
    v_dot2_f32_bf16 v28, v104, v20, v28
    v_dot2_f32_bf16 v29, v116, v20, v29
    v_dot2_f32_bf16 v30, v128, v20, v30
    v_dot2_f32_bf16 v31, v140, v20, v31
    v_dot2_f32_bf16 v28, v105, v21, v28
    v_dot2_f32_bf16 v29, v117, v21, v29
    v_dot2_f32_bf16 v30, v129, v21, v30
    v_dot2_f32_bf16 v31, v141, v21, v31
    v_dot2_f32_bf16 v28, v106, v22, v28
    v_dot2_f32_bf16 v29, v118, v22, v29
    v_dot2_f32_bf16 v30, v130, v22, v30
    v_dot2_f32_bf16 v31, v142, v22, v31
    v_dot2_f32_bf16 v28, v107, v23, v28
    v_dot2_f32_bf16 v29, v119, v23, v29
    v_dot2_f32_bf16 v30, v131, v23, v30
    v_dot2_f32_bf16 v31, v143, v23, v31
    s_nop 2
    v_add_f32_dpp v24, v24, v24 quad_perm:[1,0,3,2] row_mask:0xf bank_mask:0xf
    v_add_f32_dpp v25, v25, v25 quad_perm:[1,0,3,2] row_mask:0xf bank_mask:0xf
    v_add_f32_dpp v26, v26, v26 quad_perm:[1,0,3,2] row_mask:0xf bank_mask:0xf
    v_add_f32_dpp v27, v27, v27 quad_perm:[1,0,3,2] row_mask:0xf bank_mask:0xf
    v_add_f32_dpp v28, v28, v28 quad_perm:[1,0,3,2] row_mask:0xf bank_mask:0xf
    v_add_f32_dpp v29, v29, v29 quad_perm:[1,0,3,2] row_mask:0xf bank_mask:0xf
    v_add_f32_dpp v30, v30, v30 quad_perm:[1,0,3,2] row_mask:0xf bank_mask:0xf
    v_add_f32_dpp v31, v31, v31 quad_perm:[1,0,3,2] row_mask:0xf bank_mask:0xf
    v_add_f32_dpp v24, v24, v24 quad_perm:[2,3,0,1] row_mask:0xf bank_mask:0xf
    v_add_f32_dpp v25, v25, v25 quad_perm:[2,3,0,1] row_mask:0xf bank_mask:0xf
    v_add_f32_dpp v26, v26, v26 quad_perm:[2,3,0,1] row_mask:0xf bank_mask:0xf
    v_add_f32_dpp v27, v27, v27 quad_perm:[2,3,0,1] row_mask:0xf bank_mask:0xf
    v_add_f32_dpp v28, v28, v28 quad_perm:[2,3,0,1] row_mask:0xf bank_mask:0xf
    v_add_f32_dpp v29, v29, v29 quad_perm:[2,3,0,1] row_mask:0xf bank_mask:0xf
    v_add_f32_dpp v30, v30, v30 quad_perm:[2,3,0,1] row_mask:0xf bank_mask:0xf
    v_add_f32_dpp v31, v31, v31 quad_perm:[2,3,0,1] row_mask:0xf bank_mask:0xf
    v_add_f32_dpp v24, v24, v24 row_half_mirror row_mask:0xf bank_mask:0xf
    v_add_f32_dpp v25, v25, v25 row_half_mirror row_mask:0xf bank_mask:0xf
    v_add_f32_dpp v26, v26, v26 row_half_mirror row_mask:0xf bank_mask:0xf
    v_add_f32_dpp v27, v27, v27 row_half_mirror row_mask:0xf bank_mask:0xf
    v_add_f32_dpp v28, v28, v28 row_half_mirror row_mask:0xf bank_mask:0xf
    v_add_f32_dpp v29, v29, v29 row_half_mirror row_mask:0xf bank_mask:0xf
    v_add_f32_dpp v30, v30, v30 row_half_mirror row_mask:0xf bank_mask:0xf
    v_add_f32_dpp v31, v31, v31 row_half_mirror row_mask:0xf bank_mask:0xf
    s_mov_b32 s32, 0x3d93cd3a
    v_cvt_pk_bf16_f32 v32, v24, v25
    v_lshlrev_b32 v24, 16, v32
    v_and_b32 v25, 0xffff0000, v32
    v_mul_f32 v24, s32, v24
    v_mul_f32 v25, s32, v25
    v_cvt_pk_bf16_f32 v32, v24, v25
    v_lshlrev_b32 v24, 16, v32
    v_and_b32 v25, 0xffff0000, v32
    v_cvt_pk_bf16_f32 v32, v26, v27
    v_lshlrev_b32 v26, 16, v32
    v_and_b32 v27, 0xffff0000, v32
    v_mul_f32 v26, s32, v26
    v_mul_f32 v27, s32, v27
    v_cvt_pk_bf16_f32 v32, v26, v27
    v_lshlrev_b32 v26, 16, v32
    v_and_b32 v27, 0xffff0000, v32
    v_cvt_pk_bf16_f32 v32, v28, v29
    v_lshlrev_b32 v28, 16, v32
    v_and_b32 v29, 0xffff0000, v32
    v_mul_f32 v28, s32, v28
    v_mul_f32 v29, s32, v29
    v_cvt_pk_bf16_f32 v32, v28, v29
    v_lshlrev_b32 v28, 16, v32
    v_and_b32 v29, 0xffff0000, v32
    v_cvt_pk_bf16_f32 v32, v30, v31
    v_lshlrev_b32 v30, 16, v32
    v_and_b32 v31, 0xffff0000, v32
    v_mul_f32 v30, s32, v30
    v_mul_f32 v31, s32, v31
    v_cvt_pk_bf16_f32 v32, v30, v31
    v_lshlrev_b32 v30, 16, v32
    v_and_b32 v31, 0xffff0000, v32
    v_max3_f32 v32, v24, v25, v26
    v_max3_f32 v33, v27, v28, v29
    v_max3_f32 v32, v32, v30, v31
    v_max_f32 v32, v32, v33
    s_nop 1
    v_max_f32_dpp v32, v32, v32 row_ror:8 row_mask:0xf bank_mask:0xf
    s_nop 1
    v_max_f32_dpp v32, v32, v32 row_bcast:15 row_mask:0xa bank_mask:0xf
    s_nop 1
    v_max_f32_dpp v32, v32, v32 row_bcast:31 row_mask:0xc bank_mask:0xf
    s_nop 1
    v_readlane_b32 s45, v32, 63
    s_nop 1
    s_mov_b32 s32, 0x3fb8aa3b
    v_subrev_f32 v24, s45, v24
    v_mul_f32 v24, s32, v24
    v_exp_f32 v24, v24
    v_subrev_f32 v25, s45, v25
    v_mul_f32 v25, s32, v25
    v_exp_f32 v25, v25
    v_subrev_f32 v26, s45, v26
    v_mul_f32 v26, s32, v26
    v_exp_f32 v26, v26
    v_subrev_f32 v27, s45, v27
    v_mul_f32 v27, s32, v27
    v_exp_f32 v27, v27
    v_subrev_f32 v28, s45, v28
    v_mul_f32 v28, s32, v28
    v_exp_f32 v28, v28
    v_subrev_f32 v29, s45, v29
    v_mul_f32 v29, s32, v29
    v_exp_f32 v29, v29
    v_subrev_f32 v30, s45, v30
    v_mul_f32 v30, s32, v30
    v_exp_f32 v30, v30
    v_subrev_f32 v31, s45, v31
    v_mul_f32 v31, s32, v31
    v_exp_f32 v31, v31
    s_nop 0
    v_add_f32 v32, v24, v25
    v_add_f32 v33, v26, v27
    v_add_f32 v34, v28, v29
    v_add_f32 v35, v30, v31
    v_add_f32 v32, v32, v33
    v_add_f32 v34, v34, v35
    v_add_f32 v32, v32, v34
    s_nop 1
    v_add_f32_dpp v32, v32, v32 row_ror:8 row_mask:0xf bank_mask:0xf
    s_nop 1
    v_add_f32_dpp v32, v32, v32 row_bcast:15 row_mask:0xa bank_mask:0xf
    s_nop 1
    v_add_f32_dpp v32, v32, v32 row_bcast:31 row_mask:0xc bank_mask:0xf
    s_nop 1
    v_readlane_b32 s46, v32, 63
    s_nop 1
    s_lshl_b32 s32, s3, 3
    s_add_u32 s32, s32, 33312
    v_mov_b32 v32, s32
    v_mov_b32 v34, s45
    v_mov_b32 v35, s46
    s_mov_b64 exec, 1
    ds_write_b64 v32, v[34:35]
    s_mov_b64 exec, -1
    s_waitcnt lgkmcnt(0)
    v_mov_b32 v46, 33292
    v_mov_b32 v47, 1
    s_mov_b64 exec, 1
    ds_add_u32 v46, v47
    s_mov_b64 exec, -1
    v_cvt_pk_bf16_f32 v51, v24, v24
    v_and_b32 v48, v51, v8
    v_and_b32 v49, v51, v9
    v_and_b32 v50, v51, v10
    v_and_b32 v51, v51, v11
    v_cvt_pk_bf16_f32 v55, v25, v25
    v_and_b32 v52, v55, v8
    v_and_b32 v53, v55, v9
    v_and_b32 v54, v55, v10
    v_and_b32 v55, v55, v11
    v_cvt_pk_bf16_f32 v59, v26, v26
    v_and_b32 v56, v59, v8
    v_and_b32 v57, v59, v9
    v_and_b32 v58, v59, v10
    v_and_b32 v59, v59, v11
    v_cvt_pk_bf16_f32 v63, v27, v27
    v_and_b32 v60, v63, v8
    v_and_b32 v61, v63, v9
    v_and_b32 v62, v63, v10
    v_and_b32 v63, v63, v11
    v_cvt_pk_bf16_f32 v67, v28, v28
    v_and_b32 v64, v67, v8
    v_and_b32 v65, v67, v9
    v_and_b32 v66, v67, v10
    v_and_b32 v67, v67, v11
    v_cvt_pk_bf16_f32 v71, v29, v29
    v_and_b32 v68, v71, v8
    v_and_b32 v69, v71, v9
    v_and_b32 v70, v71, v10
    v_and_b32 v71, v71, v11
    v_cvt_pk_bf16_f32 v75, v30, v30
    v_and_b32 v72, v75, v8
    v_and_b32 v73, v75, v9
    v_and_b32 v74, v75, v10
    v_and_b32 v75, v75, v11
    v_cvt_pk_bf16_f32 v79, v31, v31
    v_and_b32 v76, v79, v8
    v_and_b32 v77, v79, v9
    v_and_b32 v78, v79, v10
    v_and_b32 v79, v79, v11
    s_waitcnt vmcnt(21)
    v_mfma_f32_16x16x32_bf16 v[80:83], v[48:51], v[144:147], 0
    v_mfma_f32_16x16x32_bf16 v[84:87], v[48:51], v[148:151], 0
    v_mfma_f32_16x16x32_bf16 v[88:91], v[48:51], v[152:155], 0
    s_waitcnt vmcnt(18)
    v_mfma_f32_16x16x32_bf16 v[80:83], v[52:55], v[156:159], v[80:83]
    v_mfma_f32_16x16x32_bf16 v[84:87], v[52:55], v[160:163], v[84:87]
    v_mfma_f32_16x16x32_bf16 v[88:91], v[52:55], v[164:167], v[88:91]
    s_waitcnt vmcnt(15)
    v_mfma_f32_16x16x32_bf16 v[80:83], v[56:59], v[168:171], v[80:83]
    v_mfma_f32_16x16x32_bf16 v[84:87], v[56:59], v[172:175], v[84:87]
    v_mfma_f32_16x16x32_bf16 v[88:91], v[56:59], v[176:179], v[88:91]
    s_waitcnt vmcnt(12)
    v_mfma_f32_16x16x32_bf16 v[80:83], v[60:63], v[180:183], v[80:83]
    v_mfma_f32_16x16x32_bf16 v[84:87], v[60:63], v[184:187], v[84:87]
    v_mfma_f32_16x16x32_bf16 v[88:91], v[60:63], v[188:191], v[88:91]
    s_waitcnt vmcnt(9)
    v_mfma_f32_16x16x32_bf16 v[80:83], v[64:67], v[192:195], v[80:83]
    v_mfma_f32_16x16x32_bf16 v[84:87], v[64:67], v[196:199], v[84:87]
    v_mfma_f32_16x16x32_bf16 v[88:91], v[64:67], v[200:203], v[88:91]
    s_waitcnt vmcnt(6)
    v_mfma_f32_16x16x32_bf16 v[80:83], v[68:71], v[204:207], v[80:83]
    v_mfma_f32_16x16x32_bf16 v[84:87], v[68:71], v[208:211], v[84:87]
    v_mfma_f32_16x16x32_bf16 v[88:91], v[68:71], v[212:215], v[88:91]
    s_waitcnt vmcnt(3)
    v_mfma_f32_16x16x32_bf16 v[80:83], v[72:75], v[216:219], v[80:83]
    v_mfma_f32_16x16x32_bf16 v[84:87], v[72:75], v[220:223], v[84:87]
    v_mfma_f32_16x16x32_bf16 v[88:91], v[72:75], v[224:227], v[88:91]
    s_waitcnt vmcnt(0)
    v_mfma_f32_16x16x32_bf16 v[80:83], v[76:79], v[228:231], v[80:83]
    v_mfma_f32_16x16x32_bf16 v[84:87], v[76:79], v[232:235], v[84:87]
    v_mfma_f32_16x16x32_bf16 v[88:91], v[76:79], v[236:239], v[88:91]
    v_mov_b32 v46, 33292
Lcw_34:
    ds_read_b32 v47, v46
    s_waitcnt lgkmcnt(0)
    v_readfirstlane_b32 s32, v47
    s_add_u32 s44, s44, 1
    s_cmp_ge_u32 s32, 8
    s_cbranch_scc1 Lcok_35
    s_cmp_gt_u32 s44, 4000000
    s_cbranch_scc1 Lcok_35
    s_sleep 1
    s_branch Lcw_34
Lcok_35:
    v_lshlrev_b32 v32, 3, v4
    ds_read_b64 v[34:35], v32 offset:33312
    s_waitcnt lgkmcnt(0)
    v_mov_b32 v36, v34
    s_nop 1
    s_nop 1
    v_max_f32_dpp v36, v36, v36 quad_perm:[1,0,3,2] row_mask:0xf bank_mask:0xf
    s_nop 1
    v_max_f32_dpp v36, v36, v36 quad_perm:[2,3,0,1] row_mask:0xf bank_mask:0xf
    s_nop 1
    v_max_f32_dpp v36, v36, v36 row_half_mirror row_mask:0xf bank_mask:0xf
    s_mov_b32 s32, 0x3fb8aa3b
    v_sub_f32 v7, s45, v36
    v_mul_f32 v7, s32, v7
    v_exp_f32 v7, v7
    s_cmp_eq_u32 s3, 0
    s_cbranch_scc0 Lskip_ml_36
    v_sub_f32 v37, v34, v36
    v_mul_f32 v37, s32, v37
    v_exp_f32 v37, v37
    s_nop 0
    v_mul_f32 v37, v37, v35
    s_nop 1
    s_nop 1
    v_add_f32_dpp v37, v37, v37 quad_perm:[1,0,3,2] row_mask:0xf bank_mask:0xf
    s_nop 1
    v_add_f32_dpp v37, v37, v37 quad_perm:[2,3,0,1] row_mask:0xf bank_mask:0xf
    s_nop 1
    v_add_f32_dpp v37, v37, v37 row_half_mirror row_mask:0xf bank_mask:0xf
    v_mov_b32 v38, v36
    v_mov_b32 v39, v37
    v_bfi_b32 v36, v6, s95, v36
    v_bfi_b32 v37, v6, s95, v37
    v_bfi_b32 v38, v6, s95, v38
    v_bfi_b32 v39, v6, s95, v39
    s_lshl_b32 s33, s30, 3
    s_add_u32 s33, s33, s31
    s_mul_i32 s33, s33, 640
    v_mov_b32 v32, s33
    s_mov_b64 exec, 1
    global_store_dwordx4 v32, v[36:39], s[56:57] sc1
    s_mov_b64 exec, -1
Lskip_ml_36:
    v_lshrrev_b32 v32, 5, v1
    s_lshl_b32 s32, s3, 1
    v_add_u32 v32, s32, v32
    v_mul_u32_u24 v32, 768, v32
    v_add_u32 v32, v32, v5
    s_nop 3
    v_mul_f32 v80, v7, v80
    v_mul_f32 v81, v7, v81
    v_mul_f32 v82, v7, v82
    v_mul_f32 v83, v7, v83
    v_mul_f32 v84, v7, v84
    v_mul_f32 v85, v7, v85
    v_mul_f32 v86, v7, v86
    v_mul_f32 v87, v7, v87
    v_mul_f32 v88, v7, v88
    v_mul_f32 v89, v7, v89
    v_mul_f32 v90, v7, v90
    v_mul_f32 v91, v7, v91
    s_mov_b32 exec_lo, 0x00ff00ff
    s_mov_b32 exec_hi, 0xff00ff00
    ds_write_b128 v32, v[80:83] offset:0
    ds_write_b128 v32, v[84:87] offset:256
    ds_write_b128 v32, v[88:91] offset:512
    s_mov_b64 exec, -1
    s_setprio 1
    s_branch L_tail_l
L_worker_l:
    s_sub_u32 s49, s3, 4
    global_load_dwordx4 v[48:51], v2, s[6:7] offset:0 nt
    global_load_dwordx4 v[52:55], v2, s[6:7] offset:128 nt
    v_mov_b32 v40, 33280
    v_mov_b32 v42, 0
    v_mov_b32 v43, 0
    v_mov_b32 v44, 0
    v_mov_b32 v45, 0
    s_mov_b64 exec, 1
    ds_write_b128 v40, v[42:45]
    ds_write_b128 v40, v[42:45] offset:16
    s_mov_b64 exec, -1
    s_waitcnt lgkmcnt(0)
    s_barrier
    s_load_dword s58, s[26:27], 0xf0000
    global_load_dwordx4 v[56:59], v2, s[6:7] offset:256 nt
    global_load_dwordx4 v[60:63], v2, s[6:7] offset:3072 nt
    global_load_dwordx4 v[64:67], v2, s[6:7] offset:3200 nt
    global_load_dwordx4 v[68:71], v2, s[6:7] offset:3328 nt
    s_add_u32 s6, s6, 6144
    s_addc_u32 s7, s7, 0
    global_load_dwordx4 v[72:75], v2, s[6:7] offset:0 nt
    global_load_dwordx4 v[76:79], v2, s[6:7] offset:128 nt
    v_and_b32 v32, 1, v1
    v_lshlrev_b32 v32, 4, v32
    v_mov_b32 v33, 0xffff
    v_lshlrev_b32 v33, v32, v33
    v_bfe_u32 v34, v1, 1, 2
    v_cmp_eq_u32 s[36:37], 0, v34
    v_cmp_eq_u32 s[38:39], 1, v34
    v_cmp_eq_u32 s[40:41], 2, v34
    v_cmp_eq_u32 s[42:43], 3, v34
    s_nop 0
    v_cndmask_b32 v8, 0, v33, s[36:37]
    v_cndmask_b32 v9, 0, v33, s[38:39]
    v_cndmask_b32 v10, 0, v33, s[40:41]
    v_cndmask_b32 v11, 0, v33, s[42:43]
    v_bfe_u32 v32, v1, 4, 1
    v_lshlrev_b32 v32, 4, v32
    v_lshl_add_u32 v5, v4, 5, v32
    v_mov_b32 v6, 0xff
    s_mov_b32 s92, 0x0c0c0400
    s_mov_b32 s93, 0x0c040100
    s_mov_b32 s94, 0x04020100
    s_add_u32 s54, s26, 0x80000
    s_addc_u32 s55, s27, 0
    s_add_u32 s56, s26, 0xb0000
    s_addc_u32 s57, s27, 0
    s_waitcnt lgkmcnt(0)
    s_add_u32 s58, s58, 1
    s_and_b32 s95, s58, 0xff
    s_mul_i32 s59, s95, 0x01010101
    s_setprio 1
    global_load_dwordx4 v[80:83], v2, s[6:7] offset:256 nt
    global_load_dwordx4 v[84:87], v2, s[6:7] offset:3072 nt
    global_load_dwordx4 v[88:91], v2, s[6:7] offset:3200 nt
    global_load_dwordx4 v[92:95], v2, s[6:7] offset:3328 nt
    s_add_u32 s6, s6, 6144
    s_addc_u32 s7, s7, 0
    global_load_dwordx4 v[96:99], v2, s[6:7] offset:0 nt
    global_load_dwordx4 v[100:103], v2, s[6:7] offset:128 nt
    global_load_dwordx4 v[104:107], v2, s[6:7] offset:256 nt
    global_load_dwordx4 v[108:111], v2, s[6:7] offset:3072 nt
    global_load_dwordx4 v[112:115], v2, s[6:7] offset:3200 nt
    global_load_dwordx4 v[116:119], v2, s[6:7] offset:3328 nt
    s_add_u32 s6, s6, 6144
    s_addc_u32 s7, s7, 0
    global_load_dwordx4 v[120:123], v2, s[6:7] offset:0 nt
    global_load_dwordx4 v[124:127], v2, s[6:7] offset:128 nt
    global_load_dwordx4 v[128:131], v2, s[6:7] offset:256 nt
    global_load_dwordx4 v[132:135], v2, s[6:7] offset:3072 nt
    global_load_dwordx4 v[136:139], v2, s[6:7] offset:3200 nt
    global_load_dwordx4 v[140:143], v2, s[6:7] offset:3328 nt
    s_mul_i32 s32, s30, 5120
    s_lshl_b32 s33, s49, 8
    s_add_u32 s32, s32, s33
    v_min_u32 v33, 4, v4
    v_mul_u32_u24 v33, 1024, v33
    v_lshl_add_u32 v34, v3, 4, v33
    v_add_u32 v248, s32, v34
    v_mov_b32 v240, 0
    v_mov_b32 v241, 0
    v_mov_b32 v242, 0
    v_mov_b32 v243, s58
    v_mov_b32 v244, 0
    v_mov_b32 v245, 0
    v_mov_b32 v246, 0
    v_mov_b32 v247, s58
    s_mov_b32 exec_lo, 0x1f1f1f1f
    s_mov_b32 exec_hi, 0x1f1f1f1f
    global_load_dwordx4 v[240:243], v248, s[26:27] offset:0 sc1
    global_load_dwordx4 v[244:247], v248, s[26:27] offset:128 sc1
    s_mov_b64 exec, -1
    global_load_dwordx4 v[144:147], v2, s[8:9] offset:0 nt
    global_load_dwordx4 v[148:151], v2, s[8:9] offset:128 nt
    global_load_dwordx4 v[152:155], v2, s[8:9] offset:256 nt
    global_load_dwordx4 v[156:159], v2, s[8:9] offset:3072 nt
    global_load_dwordx4 v[160:163], v2, s[8:9] offset:3200 nt
    global_load_dwordx4 v[164:167], v2, s[8:9] offset:3328 nt
    s_add_u32 s8, s8, 6144
    s_addc_u32 s9, s9, 0
    global_load_dwordx4 v[168:171], v2, s[8:9] offset:0 nt
    global_load_dwordx4 v[172:175], v2, s[8:9] offset:128 nt
    global_load_dwordx4 v[176:179], v2, s[8:9] offset:256 nt
    global_load_dwordx4 v[180:183], v2, s[8:9] offset:3072 nt
    s_waitcnt vmcnt(10)
    v_xor_b32 v34, s58, v243
    v_xor_b32 v35, s58, v247
    v_or_b32 v34, v34, v35
    v_cmp_ne_u32 vcc, 0, v34
    s_cbranch_vccz Lok_q_37
Lre_q_38:
    s_add_u32 s44, s44, 1
    s_cmp_gt_u32 s44, 200000
    s_cbranch_scc1 Lok_q_37
    s_sleep 2
    s_mov_b64 exec, vcc
    global_load_dwordx4 v[240:243], v248, s[26:27] offset:0 sc1
    global_load_dwordx4 v[244:247], v248, s[26:27] offset:128 sc1
    s_mov_b64 exec, -1
    s_waitcnt vmcnt(0)
    v_xor_b32 v34, s58, v243
    v_xor_b32 v35, s58, v247
    v_or_b32 v34, v34, v35
    v_cmp_ne_u32 vcc, 0, v34
    s_cbranch_vccnz Lre_q_38
Lok_q_37:
    v_add_f32_dpp v240, v240, v240 quad_perm:[1,0,3,2] row_mask:0xf bank_mask:0xf
    v_add_f32_dpp v241, v241, v241 quad_perm:[1,0,3,2] row_mask:0xf bank_mask:0xf
    v_add_f32_dpp v242, v242, v242 quad_perm:[1,0,3,2] row_mask:0xf bank_mask:0xf
    v_add_f32_dpp v244, v244, v244 quad_perm:[1,0,3,2] row_mask:0xf bank_mask:0xf
    v_add_f32_dpp v245, v245, v245 quad_perm:[1,0,3,2] row_mask:0xf bank_mask:0xf
    v_add_f32_dpp v246, v246, v246 quad_perm:[1,0,3,2] row_mask:0xf bank_mask:0xf
    v_add_f32_dpp v240, v240, v240 quad_perm:[2,3,0,1] row_mask:0xf bank_mask:0xf
    v_add_f32_dpp v241, v241, v241 quad_perm:[2,3,0,1] row_mask:0xf bank_mask:0xf
    v_add_f32_dpp v242, v242, v242 quad_perm:[2,3,0,1] row_mask:0xf bank_mask:0xf
    v_add_f32_dpp v244, v244, v244 quad_perm:[2,3,0,1] row_mask:0xf bank_mask:0xf
    v_add_f32_dpp v245, v245, v245 quad_perm:[2,3,0,1] row_mask:0xf bank_mask:0xf
    v_add_f32_dpp v246, v246, v246 quad_perm:[2,3,0,1] row_mask:0xf bank_mask:0xf
    v_add_f32_dpp v240, v240, v240 row_half_mirror row_mask:0xf bank_mask:0xf
    v_add_f32_dpp v241, v241, v241 row_half_mirror row_mask:0xf bank_mask:0xf
    v_add_f32_dpp v242, v242, v242 row_half_mirror row_mask:0xf bank_mask:0xf
    v_add_f32_dpp v244, v244, v244 row_half_mirror row_mask:0xf bank_mask:0xf
    v_add_f32_dpp v245, v245, v245 row_half_mirror row_mask:0xf bank_mask:0xf
    v_add_f32_dpp v246, v246, v246 row_half_mirror row_mask:0xf bank_mask:0xf
    s_mul_i32 s32, s49, 96
    s_add_u32 s32, s32, 24576
    v_mul_u32_u24 v38, 6, v3
    v_add_u32 v38, s32, v38
    v_cvt_pk_bf16_f32 v32, v240, v241
    v_cvt_pk_bf16_f32 v33, v242, v242
    v_cvt_pk_bf16_f32 v34, v244, v245
    v_cvt_pk_bf16_f32 v35, v246, v246
    s_mov_b32 exec_lo, 0x01010101
    s_mov_b32 exec_hi, 0x01010101
    ds_write_b16 v38, v32 offset:0
    ds_write_b16_d16_hi v38, v32 offset:2
    ds_write_b16 v38, v33 offset:4
    ds_write_b16 v38, v34 offset:48
    ds_write_b16_d16_hi v38, v34 offset:50
    ds_write_b16 v38, v35 offset:52
    s_mov_b64 exec, -1
    s_waitcnt lgkmcnt(0)
    v_mov_b32 v46, 33284
    v_mov_b32 v47, 1
    s_mov_b64 exec, 1
    ds_add_u32 v46, v47
    s_mov_b64 exec, -1
    v_mov_b32 v46, 33284
Lcw_39:
    ds_read_b32 v47, v46
    s_waitcnt lgkmcnt(0)
    v_readfirstlane_b32 s32, v47
    s_add_u32 s44, s44, 1
    s_cmp_ge_u32 s32, 4
    s_cbranch_scc1 Lcok_40
    s_cmp_gt_u32 s44, 4000000
    s_cbranch_scc1 Lcok_40
    s_sleep 1
    s_branch Lcw_39
Lcok_40:
    v_lshlrev_b32 v32, 4, v4
    ds_read_b128 v[12:15], v32 offset:24576
    ds_read_b128 v[16:19], v32 offset:24704
    ds_read_b128 v[20:23], v32 offset:24832
    s_waitcnt lgkmcnt(0)
    s_waitcnt vmcnt(24)
    v_dot2_f32_bf16 v24, v48, v12, 0
    v_dot2_f32_bf16 v25, v60, v12, 0
    v_dot2_f32_bf16 v26, v72, v12, 0
    v_dot2_f32_bf16 v27, v84, v12, 0
    v_dot2_f32_bf16 v24, v49, v13, v24
    v_dot2_f32_bf16 v25, v61, v13, v25
    v_dot2_f32_bf16 v26, v73, v13, v26
    v_dot2_f32_bf16 v27, v85, v13, v27
    v_dot2_f32_bf16 v24, v50, v14, v24
    v_dot2_f32_bf16 v25, v62, v14, v25
    v_dot2_f32_bf16 v26, v74, v14, v26
    v_dot2_f32_bf16 v27, v86, v14, v27
    v_dot2_f32_bf16 v24, v51, v15, v24
    v_dot2_f32_bf16 v25, v63, v15, v25
    v_dot2_f32_bf16 v26, v75, v15, v26
    v_dot2_f32_bf16 v27, v87, v15, v27
    v_dot2_f32_bf16 v24, v52, v16, v24
    v_dot2_f32_bf16 v25, v64, v16, v25
    v_dot2_f32_bf16 v26, v76, v16, v26
    v_dot2_f32_bf16 v27, v88, v16, v27
    v_dot2_f32_bf16 v24, v53, v17, v24
    v_dot2_f32_bf16 v25, v65, v17, v25
    v_dot2_f32_bf16 v26, v77, v17, v26
    v_dot2_f32_bf16 v27, v89, v17, v27
    v_dot2_f32_bf16 v24, v54, v18, v24
    v_dot2_f32_bf16 v25, v66, v18, v25
    v_dot2_f32_bf16 v26, v78, v18, v26
    v_dot2_f32_bf16 v27, v90, v18, v27
    v_dot2_f32_bf16 v24, v55, v19, v24
    v_dot2_f32_bf16 v25, v67, v19, v25
    v_dot2_f32_bf16 v26, v79, v19, v26
    v_dot2_f32_bf16 v27, v91, v19, v27
    v_dot2_f32_bf16 v24, v56, v20, v24
    v_dot2_f32_bf16 v25, v68, v20, v25
    v_dot2_f32_bf16 v26, v80, v20, v26
    v_dot2_f32_bf16 v27, v92, v20, v27
    v_dot2_f32_bf16 v24, v57, v21, v24
    v_dot2_f32_bf16 v25, v69, v21, v25
    v_dot2_f32_bf16 v26, v81, v21, v26
    v_dot2_f32_bf16 v27, v93, v21, v27
    v_dot2_f32_bf16 v24, v58, v22, v24
    v_dot2_f32_bf16 v25, v70, v22, v25
    v_dot2_f32_bf16 v26, v82, v22, v26
    v_dot2_f32_bf16 v27, v94, v22, v27
    v_dot2_f32_bf16 v24, v59, v23, v24
    v_dot2_f32_bf16 v25, v71, v23, v25
    v_dot2_f32_bf16 v26, v83, v23, v26
    v_dot2_f32_bf16 v27, v95, v23, v27
    global_load_dwordx4 v[184:187], v2, s[8:9] offset:3200 nt
    global_load_dwordx4 v[188:191], v2, s[8:9] offset:3328 nt
    s_waitcnt vmcnt(14)
    v_dot2_f32_bf16 v28, v96, v12, 0
    v_dot2_f32_bf16 v29, v108, v12, 0
    v_dot2_f32_bf16 v30, v120, v12, 0
    v_dot2_f32_bf16 v31, v132, v12, 0
    v_dot2_f32_bf16 v28, v97, v13, v28
    v_dot2_f32_bf16 v29, v109, v13, v29
    v_dot2_f32_bf16 v30, v121, v13, v30
    v_dot2_f32_bf16 v31, v133, v13, v31
    v_dot2_f32_bf16 v28, v98, v14, v28
    v_dot2_f32_bf16 v29, v110, v14, v29
    v_dot2_f32_bf16 v30, v122, v14, v30
    v_dot2_f32_bf16 v31, v134, v14, v31
    v_dot2_f32_bf16 v28, v99, v15, v28
    v_dot2_f32_bf16 v29, v111, v15, v29
    v_dot2_f32_bf16 v30, v123, v15, v30
    v_dot2_f32_bf16 v31, v135, v15, v31
    v_dot2_f32_bf16 v28, v100, v16, v28
    v_dot2_f32_bf16 v29, v112, v16, v29
    v_dot2_f32_bf16 v30, v124, v16, v30
    v_dot2_f32_bf16 v31, v136, v16, v31
    v_dot2_f32_bf16 v28, v101, v17, v28
    v_dot2_f32_bf16 v29, v113, v17, v29
    v_dot2_f32_bf16 v30, v125, v17, v30
    v_dot2_f32_bf16 v31, v137, v17, v31
    v_dot2_f32_bf16 v28, v102, v18, v28
    v_dot2_f32_bf16 v29, v114, v18, v29
    v_dot2_f32_bf16 v30, v126, v18, v30
    v_dot2_f32_bf16 v31, v138, v18, v31
    v_dot2_f32_bf16 v28, v103, v19, v28
    v_dot2_f32_bf16 v29, v115, v19, v29
    v_dot2_f32_bf16 v30, v127, v19, v30
    v_dot2_f32_bf16 v31, v139, v19, v31
    v_dot2_f32_bf16 v28, v104, v20, v28
    v_dot2_f32_bf16 v29, v116, v20, v29
    v_dot2_f32_bf16 v30, v128, v20, v30
    v_dot2_f32_bf16 v31, v140, v20, v31
    v_dot2_f32_bf16 v28, v105, v21, v28
    v_dot2_f32_bf16 v29, v117, v21, v29
    v_dot2_f32_bf16 v30, v129, v21, v30
    v_dot2_f32_bf16 v31, v141, v21, v31
    v_dot2_f32_bf16 v28, v106, v22, v28
    v_dot2_f32_bf16 v29, v118, v22, v29
    v_dot2_f32_bf16 v30, v130, v22, v30
    v_dot2_f32_bf16 v31, v142, v22, v31
    v_dot2_f32_bf16 v28, v107, v23, v28
    v_dot2_f32_bf16 v29, v119, v23, v29
    v_dot2_f32_bf16 v30, v131, v23, v30
    v_dot2_f32_bf16 v31, v143, v23, v31
    s_add_u32 s8, s8, 6144
    s_addc_u32 s9, s9, 0
    global_load_dwordx4 v[192:195], v2, s[8:9] offset:0 nt
    global_load_dwordx4 v[196:199], v2, s[8:9] offset:128 nt
    s_nop 2
    v_add_f32_dpp v24, v24, v24 quad_perm:[1,0,3,2] row_mask:0xf bank_mask:0xf
    v_add_f32_dpp v25, v25, v25 quad_perm:[1,0,3,2] row_mask:0xf bank_mask:0xf
    v_add_f32_dpp v26, v26, v26 quad_perm:[1,0,3,2] row_mask:0xf bank_mask:0xf
    v_add_f32_dpp v27, v27, v27 quad_perm:[1,0,3,2] row_mask:0xf bank_mask:0xf
    v_add_f32_dpp v28, v28, v28 quad_perm:[1,0,3,2] row_mask:0xf bank_mask:0xf
    v_add_f32_dpp v29, v29, v29 quad_perm:[1,0,3,2] row_mask:0xf bank_mask:0xf
    v_add_f32_dpp v30, v30, v30 quad_perm:[1,0,3,2] row_mask:0xf bank_mask:0xf
    v_add_f32_dpp v31, v31, v31 quad_perm:[1,0,3,2] row_mask:0xf bank_mask:0xf
    v_add_f32_dpp v24, v24, v24 quad_perm:[2,3,0,1] row_mask:0xf bank_mask:0xf
    v_add_f32_dpp v25, v25, v25 quad_perm:[2,3,0,1] row_mask:0xf bank_mask:0xf
    v_add_f32_dpp v26, v26, v26 quad_perm:[2,3,0,1] row_mask:0xf bank_mask:0xf
    v_add_f32_dpp v27, v27, v27 quad_perm:[2,3,0,1] row_mask:0xf bank_mask:0xf
    v_add_f32_dpp v28, v28, v28 quad_perm:[2,3,0,1] row_mask:0xf bank_mask:0xf
    v_add_f32_dpp v29, v29, v29 quad_perm:[2,3,0,1] row_mask:0xf bank_mask:0xf
    v_add_f32_dpp v30, v30, v30 quad_perm:[2,3,0,1] row_mask:0xf bank_mask:0xf
    v_add_f32_dpp v31, v31, v31 quad_perm:[2,3,0,1] row_mask:0xf bank_mask:0xf
    v_add_f32_dpp v24, v24, v24 row_half_mirror row_mask:0xf bank_mask:0xf
    v_add_f32_dpp v25, v25, v25 row_half_mirror row_mask:0xf bank_mask:0xf
    v_add_f32_dpp v26, v26, v26 row_half_mirror row_mask:0xf bank_mask:0xf
    v_add_f32_dpp v27, v27, v27 row_half_mirror row_mask:0xf bank_mask:0xf
    v_add_f32_dpp v28, v28, v28 row_half_mirror row_mask:0xf bank_mask:0xf
    v_add_f32_dpp v29, v29, v29 row_half_mirror row_mask:0xf bank_mask:0xf
    v_add_f32_dpp v30, v30, v30 row_half_mirror row_mask:0xf bank_mask:0xf
    v_add_f32_dpp v31, v31, v31 row_half_mirror row_mask:0xf bank_mask:0xf
    s_mov_b32 s32, 0x3d93cd3a
    v_cvt_pk_bf16_f32 v32, v24, v25
    v_lshlrev_b32 v24, 16, v32
    v_and_b32 v25, 0xffff0000, v32
    v_mul_f32 v24, s32, v24
    v_mul_f32 v25, s32, v25
    v_cvt_pk_bf16_f32 v32, v24, v25
    v_lshlrev_b32 v24, 16, v32
    v_and_b32 v25, 0xffff0000, v32
    v_cvt_pk_bf16_f32 v32, v26, v27
    v_lshlrev_b32 v26, 16, v32
    v_and_b32 v27, 0xffff0000, v32
    v_mul_f32 v26, s32, v26
    v_mul_f32 v27, s32, v27
    v_cvt_pk_bf16_f32 v32, v26, v27
    v_lshlrev_b32 v26, 16, v32
    v_and_b32 v27, 0xffff0000, v32
    v_cvt_pk_bf16_f32 v32, v28, v29
    v_lshlrev_b32 v28, 16, v32
    v_and_b32 v29, 0xffff0000, v32
    v_mul_f32 v28, s32, v28
    v_mul_f32 v29, s32, v29
    v_cvt_pk_bf16_f32 v32, v28, v29
    v_lshlrev_b32 v28, 16, v32
    v_and_b32 v29, 0xffff0000, v32
    v_cvt_pk_bf16_f32 v32, v30, v31
    v_lshlrev_b32 v30, 16, v32
    v_and_b32 v31, 0xffff0000, v32
    v_mul_f32 v30, s32, v30
    v_mul_f32 v31, s32, v31
    v_cvt_pk_bf16_f32 v32, v30, v31
    v_lshlrev_b32 v30, 16, v32
    v_and_b32 v31, 0xffff0000, v32
    v_max3_f32 v32, v24, v25, v26
    v_max3_f32 v33, v27, v28, v29
    v_max3_f32 v32, v32, v30, v31
    v_max_f32 v32, v32, v33
    s_nop 1
    v_max_f32_dpp v32, v32, v32 row_ror:8 row_mask:0xf bank_mask:0xf
    s_nop 1
    v_max_f32_dpp v32, v32, v32 row_bcast:15 row_mask:0xa bank_mask:0xf
    s_nop 1
    v_max_f32_dpp v32, v32, v32 row_bcast:31 row_mask:0xc bank_mask:0xf
    s_nop 1
    v_readlane_b32 s45, v32, 63
    s_nop 1
    s_mov_b32 s32, 0x3fb8aa3b
    v_subrev_f32 v24, s45, v24
    v_mul_f32 v24, s32, v24
    v_exp_f32 v24, v24
    v_subrev_f32 v25, s45, v25
    v_mul_f32 v25, s32, v25
    v_exp_f32 v25, v25
    v_subrev_f32 v26, s45, v26
    v_mul_f32 v26, s32, v26
    v_exp_f32 v26, v26
    v_subrev_f32 v27, s45, v27
    v_mul_f32 v27, s32, v27
    v_exp_f32 v27, v27
    v_subrev_f32 v28, s45, v28
    v_mul_f32 v28, s32, v28
    v_exp_f32 v28, v28
    v_subrev_f32 v29, s45, v29
    v_mul_f32 v29, s32, v29
    v_exp_f32 v29, v29
    v_subrev_f32 v30, s45, v30
    v_mul_f32 v30, s32, v30
    v_exp_f32 v30, v30
    v_subrev_f32 v31, s45, v31
    v_mul_f32 v31, s32, v31
    v_exp_f32 v31, v31
    s_nop 0
    v_add_f32 v32, v24, v25
    v_add_f32 v33, v26, v27
    v_add_f32 v34, v28, v29
    v_add_f32 v35, v30, v31
    v_add_f32 v32, v32, v33
    v_add_f32 v34, v34, v35
    v_add_f32 v32, v32, v34
    s_nop 1
    v_add_f32_dpp v32, v32, v32 row_ror:8 row_mask:0xf bank_mask:0xf
    s_nop 1
    v_add_f32_dpp v32, v32, v32 row_bcast:15 row_mask:0xa bank_mask:0xf
    s_nop 1
    v_add_f32_dpp v32, v32, v32 row_bcast:31 row_mask:0xc bank_mask:0xf
    s_nop 1
    v_readlane_b32 s46, v32, 63
    s_nop 1
    s_lshl_b32 s32, s3, 3
    s_add_u32 s32, s32, 33312
    v_mov_b32 v32, s32
    v_mov_b32 v34, s45
    v_mov_b32 v35, s46
    s_mov_b64 exec, 1
    ds_write_b64 v32, v[34:35]
    s_mov_b64 exec, -1
    s_waitcnt lgkmcnt(0)
    v_mov_b32 v46, 33292
    v_mov_b32 v47, 1
    s_mov_b64 exec, 1
    ds_add_u32 v46, v47
    s_mov_b64 exec, -1
    global_load_dwordx4 v[200:203], v2, s[8:9] offset:256 nt
    global_load_dwordx4 v[204:207], v2, s[8:9] offset:3072 nt
    global_load_dwordx4 v[208:211], v2, s[8:9] offset:3200 nt
    global_load_dwordx4 v[212:215], v2, s[8:9] offset:3328 nt
    s_add_u32 s8, s8, 6144
    s_addc_u32 s9, s9, 0
    global_load_dwordx4 v[216:219], v2, s[8:9] offset:0 nt
    global_load_dwordx4 v[220:223], v2, s[8:9] offset:128 nt
    global_load_dwordx4 v[224:227], v2, s[8:9] offset:256 nt
    global_load_dwordx4 v[228:231], v2, s[8:9] offset:3072 nt
    global_load_dwordx4 v[232:235], v2, s[8:9] offset:3200 nt
    global_load_dwordx4 v[236:239], v2, s[8:9] offset:3328 nt
    v_mov_b32 v46, 33292
Lcw_41:
    ds_read_b32 v47, v46
    s_waitcnt lgkmcnt(0)
    v_readfirstlane_b32 s32, v47
    s_add_u32 s44, s44, 1
    s_cmp_ge_u32 s32, 8
    s_cbranch_scc1 Lcok_42
    s_cmp_gt_u32 s44, 4000000
    s_cbranch_scc1 Lcok_42
    s_sleep 1
    s_branch Lcw_41
Lcok_42:
    v_lshlrev_b32 v32, 3, v4
    ds_read_b64 v[34:35], v32 offset:33312
    s_waitcnt lgkmcnt(0)
    v_mov_b32 v36, v34
    s_nop 1
    s_nop 1
    v_max_f32_dpp v36, v36, v36 quad_perm:[1,0,3,2] row_mask:0xf bank_mask:0xf
    s_nop 1
    v_max_f32_dpp v36, v36, v36 quad_perm:[2,3,0,1] row_mask:0xf bank_mask:0xf
    s_nop 1
    v_max_f32_dpp v36, v36, v36 row_half_mirror row_mask:0xf bank_mask:0xf
    s_mov_b32 s32, 0x3fb8aa3b
    v_sub_f32 v7, s45, v36
    v_mul_f32 v7, s32, v7
    v_exp_f32 v7, v7
    s_cmp_eq_u32 s3, 0
    s_cbranch_scc0 Lskip_ml_43
    v_sub_f32 v37, v34, v36
    v_mul_f32 v37, s32, v37
    v_exp_f32 v37, v37
    s_nop 0
    v_mul_f32 v37, v37, v35
    s_nop 1
    s_nop 1
    v_add_f32_dpp v37, v37, v37 quad_perm:[1,0,3,2] row_mask:0xf bank_mask:0xf
    s_nop 1
    v_add_f32_dpp v37, v37, v37 quad_perm:[2,3,0,1] row_mask:0xf bank_mask:0xf
    s_nop 1
    v_add_f32_dpp v37, v37, v37 row_half_mirror row_mask:0xf bank_mask:0xf
    v_mov_b32 v38, v36
    v_mov_b32 v39, v37
    v_bfi_b32 v36, v6, s95, v36
    v_bfi_b32 v37, v6, s95, v37
    v_bfi_b32 v38, v6, s95, v38
    v_bfi_b32 v39, v6, s95, v39
    s_lshl_b32 s33, s30, 3
    s_add_u32 s33, s33, s31
    s_mul_i32 s33, s33, 640
    v_mov_b32 v32, s33
    s_mov_b64 exec, 1
    global_store_dwordx4 v32, v[36:39], s[56:57] sc1
    s_mov_b64 exec, -1
Lskip_ml_43:
    v_mul_f32 v24, v7, v24
    v_mul_f32 v25, v7, v25
    v_mul_f32 v26, v7, v26
    v_mul_f32 v27, v7, v27
    v_mul_f32 v28, v7, v28
    v_mul_f32 v29, v7, v29
    v_mul_f32 v30, v7, v30
    v_mul_f32 v31, v7, v31
    v_cvt_pk_bf16_f32 v51, v24, v24
    v_and_b32 v48, v51, v8
    v_and_b32 v49, v51, v9
    v_and_b32 v50, v51, v10
    v_and_b32 v51, v51, v11
    v_cvt_pk_bf16_f32 v55, v25, v25
    v_and_b32 v52, v55, v8
    v_and_b32 v53, v55, v9
    v_and_b32 v54, v55, v10
    v_and_b32 v55, v55, v11
    v_cvt_pk_bf16_f32 v59, v26, v26
    v_and_b32 v56, v59, v8
    v_and_b32 v57, v59, v9
    v_and_b32 v58, v59, v10
    v_and_b32 v59, v59, v11
    v_cvt_pk_bf16_f32 v63, v27, v27
    v_and_b32 v60, v63, v8
    v_and_b32 v61, v63, v9
    v_and_b32 v62, v63, v10
    v_and_b32 v63, v63, v11
    v_cvt_pk_bf16_f32 v67, v28, v28
    v_and_b32 v64, v67, v8
    v_and_b32 v65, v67, v9
    v_and_b32 v66, v67, v10
    v_and_b32 v67, v67, v11
    v_cvt_pk_bf16_f32 v71, v29, v29
    v_and_b32 v68, v71, v8
    v_and_b32 v69, v71, v9
    v_and_b32 v70, v71, v10
    v_and_b32 v71, v71, v11
    v_cvt_pk_bf16_f32 v75, v30, v30
    v_and_b32 v72, v75, v8
    v_and_b32 v73, v75, v9
    v_and_b32 v74, v75, v10
    v_and_b32 v75, v75, v11
    v_cvt_pk_bf16_f32 v79, v31, v31
    v_and_b32 v76, v79, v8
    v_and_b32 v77, v79, v9
    v_and_b32 v78, v79, v10
    v_and_b32 v79, v79, v11
    s_waitcnt vmcnt(21)
    v_mfma_f32_16x16x32_bf16 v[80:83], v[48:51], v[144:147], 0
    v_mfma_f32_16x16x32_bf16 v[84:87], v[48:51], v[148:151], 0
    v_mfma_f32_16x16x32_bf16 v[88:91], v[48:51], v[152:155], 0
    s_waitcnt vmcnt(18)
    v_mfma_f32_16x16x32_bf16 v[80:83], v[52:55], v[156:159], v[80:83]
    v_mfma_f32_16x16x32_bf16 v[84:87], v[52:55], v[160:163], v[84:87]
    v_mfma_f32_16x16x32_bf16 v[88:91], v[52:55], v[164:167], v[88:91]
    s_waitcnt vmcnt(15)
    v_mfma_f32_16x16x32_bf16 v[80:83], v[56:59], v[168:171], v[80:83]
    v_mfma_f32_16x16x32_bf16 v[84:87], v[56:59], v[172:175], v[84:87]
    v_mfma_f32_16x16x32_bf16 v[88:91], v[56:59], v[176:179], v[88:91]
    s_waitcnt vmcnt(12)
    v_mfma_f32_16x16x32_bf16 v[80:83], v[60:63], v[180:183], v[80:83]
    v_mfma_f32_16x16x32_bf16 v[84:87], v[60:63], v[184:187], v[84:87]
    v_mfma_f32_16x16x32_bf16 v[88:91], v[60:63], v[188:191], v[88:91]
    s_waitcnt vmcnt(9)
    v_mfma_f32_16x16x32_bf16 v[80:83], v[64:67], v[192:195], v[80:83]
    v_mfma_f32_16x16x32_bf16 v[84:87], v[64:67], v[196:199], v[84:87]
    v_mfma_f32_16x16x32_bf16 v[88:91], v[64:67], v[200:203], v[88:91]
    s_waitcnt vmcnt(6)
    v_mfma_f32_16x16x32_bf16 v[80:83], v[68:71], v[204:207], v[80:83]
    v_mfma_f32_16x16x32_bf16 v[84:87], v[68:71], v[208:211], v[84:87]
    v_mfma_f32_16x16x32_bf16 v[88:91], v[68:71], v[212:215], v[88:91]
    s_waitcnt vmcnt(3)
    v_mfma_f32_16x16x32_bf16 v[80:83], v[72:75], v[216:219], v[80:83]
    v_mfma_f32_16x16x32_bf16 v[84:87], v[72:75], v[220:223], v[84:87]
    v_mfma_f32_16x16x32_bf16 v[88:91], v[72:75], v[224:227], v[88:91]
    s_waitcnt vmcnt(0)
    v_mfma_f32_16x16x32_bf16 v[80:83], v[76:79], v[228:231], v[80:83]
    v_mfma_f32_16x16x32_bf16 v[84:87], v[76:79], v[232:235], v[84:87]
    v_mfma_f32_16x16x32_bf16 v[88:91], v[76:79], v[236:239], v[88:91]
    v_lshrrev_b32 v32, 5, v1
    s_lshl_b32 s32, s3, 1
    v_add_u32 v32, s32, v32
    v_mul_u32_u24 v32, 768, v32
    v_add_u32 v32, v32, v5
    s_nop 3
    s_mov_b32 exec_lo, 0x00ff00ff
    s_mov_b32 exec_hi, 0xff00ff00
    ds_write_b128 v32, v[80:83] offset:0
    ds_write_b128 v32, v[84:87] offset:256
    ds_write_b128 v32, v[88:91] offset:512
    s_mov_b64 exec, -1
L_tail_l:
    s_lshl_b32 s32, s3, 7
    v_lshl_add_u32 v33, v3, 4, s32
    v_mul_u32_u24 v34, 1536, v4
    v_add_u32 v34, v33, v34
    s_lshl_b32 s32, s30, 3
    s_add_u32 s32, s32, s31
    s_mul_i32 s32, s32, 768
    v_add_u32 v35, s32, v33
    s_waitcnt lgkmcnt(0)
    s_barrier
    s_cmp_lt_u32 s3, 6
    s_cbranch_scc0 Lskip_o_44
    ds_read_b128 v[240:243], v34 offset:0
    ds_read_b128 v[244:247], v34 offset:768
    s_waitcnt lgkmcnt(0)
    v_pk_add_f32 v[240:241], v[240:241], v[244:245]
    v_pk_add_f32 v[242:243], v[242:243], v[246:247]
    s_nop 1
    v_add_f32_dpp v240, v240, v240 quad_perm:[1,0,3,2] row_mask:0xf bank_mask:0xf
    v_add_f32_dpp v241, v241, v241 quad_perm:[1,0,3,2] row_mask:0xf bank_mask:0xf
    v_add_f32_dpp v242, v242, v242 quad_perm:[1,0,3,2] row_mask:0xf bank_mask:0xf
    v_add_f32_dpp v243, v243, v243 quad_perm:[1,0,3,2] row_mask:0xf bank_mask:0xf
    v_add_f32_dpp v240, v240, v240 quad_perm:[2,3,0,1] row_mask:0xf bank_mask:0xf
    v_add_f32_dpp v241, v241, v241 quad_perm:[2,3,0,1] row_mask:0xf bank_mask:0xf
    v_add_f32_dpp v242, v242, v242 quad_perm:[2,3,0,1] row_mask:0xf bank_mask:0xf
    v_add_f32_dpp v243, v243, v243 quad_perm:[2,3,0,1] row_mask:0xf bank_mask:0xf
    v_add_f32_dpp v240, v240, v240 row_half_mirror row_mask:0xf bank_mask:0xf
    v_add_f32_dpp v241, v241, v241 row_half_mirror row_mask:0xf bank_mask:0xf
    v_add_f32_dpp v242, v242, v242 row_half_mirror row_mask:0xf bank_mask:0xf
    v_add_f32_dpp v243, v243, v243 row_half_mirror row_mask:0xf bank_mask:0xf
    v_bfi_b32 v240, v6, s95, v240
    v_bfi_b32 v241, v6, s95, v241
    v_bfi_b32 v242, v6, s95, v242
    v_bfi_b32 v243, v6, s95, v243
    s_mov_b32 exec_lo, 0x01010101
    s_mov_b32 exec_hi, 0x01010101
    global_store_dwordx4 v35, v[240:243], s[54:55] sc1
    s_mov_b64 exec, -1
Lskip_o_44:
    s_cmp_lt_u32 s3, 4
    s_cbranch_scc0 Lskip_fin_45
    s_cmp_lt_u32 s15, 250
    s_cbranch_scc0 Lskip_fin_45
    s_sub_u32 s35, s15, 240
    v_lshrrev_b32 v32, 2, v1
    v_mul_u32_u24 v32, 6400, v32
    v_and_b32 v33, 3, v1
    v_lshl_add_u32 v32, v33, 4, v32
    s_mul_i32 s32, s35, 640
    s_lshl_b32 s33, s3, 6
    s_add_u32 s32, s32, s33
    v_add_u32 v48, s32, v32
    v_add_u32 v49, 102400, v48
    s_lshl_b32 s32, s35, 7
    s_lshl_b32 s33, s3, 5
    s_add_u32 s32, s32, s33
    v_lshl_add_u32 v34, v33, 3, s32
    global_load_dwordx2 v[80:81], v34, s[4:5]
    v_lshlrev_b32 v35, 4, v33
    s_lshl_b32 s33, s3, 6
    v_add_u32 v35, s33, v35
    v_add_u32 v50, v48, v35
    v_add_u32 v51, v49, v35
    v_mov_b32 v68, s95
    v_mov_b32 v69, s95
    v_mov_b32 v70, s95
    v_mov_b32 v71, s95
    v_mov_b32 v60, s95
    v_mov_b32 v61, s95
    v_mov_b32 v62, s95
    v_mov_b32 v63, s95
    global_load_dwordx4 v[56:59], v48, s[56:57] offset:384 sc1
    s_mov_b32 exec_hi, 0
    global_load_dwordx4 v[60:63], v49, s[56:57] offset:384 sc1
    s_mov_b64 exec, -1
    s_waitcnt vmcnt(0)
    v_perm_b32 v35, v57, v56, s92
    v_perm_b32 v35, v58, v35, s93
    v_perm_b32 v35, v59, v35, s94
    v_xor_b32 v35, s59, v35
    v_perm_b32 v36, v61, v60, s92
    v_perm_b32 v36, v62, v36, s93
    v_perm_b32 v36, v63, v36, s94
    v_xor_b32 v36, s59, v36
    v_or_b32 v35, v35, v36
    v_cmp_ne_u32 vcc, 0, v35
    s_cbranch_vccz Lok_f_46
Lre_f_47:
    s_add_u32 s44, s44, 1
    s_cmp_gt_u32 s44, 200000
    s_cbranch_scc1 Lok_f_46
    s_sleep 2
    global_load_dwordx4 v[56:59], v48, s[56:57] offset:384 sc1
    s_mov_b32 exec_hi, 0
    global_load_dwordx4 v[60:63], v49, s[56:57] offset:384 sc1
    s_mov_b64 exec, -1
    s_waitcnt vmcnt(0)
    v_perm_b32 v35, v57, v56, s92
    v_perm_b32 v35, v58, v35, s93
    v_perm_b32 v35, v59, v35, s94
    v_xor_b32 v35, s59, v35
    v_perm_b32 v36, v61, v60, s92
    v_perm_b32 v36, v62, v36, s93
    v_perm_b32 v36, v63, v36, s94
    v_xor_b32 v36, s59, v36
    v_or_b32 v35, v35, v36
    v_cmp_ne_u32 vcc, 0, v35
    s_cbranch_vccnz Lre_f_47
Lok_f_46:
    global_load_dwordx4 v[64:67], v48, s[56:57] offset:128 sc1
    s_mov_b32 exec_hi, 0
    global_load_dwordx4 v[68:71], v49, s[56:57] offset:128 sc1
    s_mov_b64 exec, -1
    v_and_b32 v56, 0xffffff00, v56
    v_and_b32 v57, 0xffffff00, v57
    v_and_b32 v58, 0xffffff00, v58
    v_and_b32 v59, 0xffffff00, v59
    v_and_b32 v60, 0xffffff00, v60
    v_and_b32 v61, 0xffffff00, v61
    v_and_b32 v62, 0xffffff00, v62
    v_and_b32 v63, 0xffffff00, v63
    v_pk_add_f32 v[56:57], v[56:57], v[60:61]
    v_pk_add_f32 v[58:59], v[58:59], v[62:63]
    s_nop 0
    v_add_f32_dpp v56, v56, v56 row_ror:4 row_mask:0xf bank_mask:0xf
    v_add_f32_dpp v57, v57, v57 row_ror:4 row_mask:0xf bank_mask:0xf
    v_add_f32_dpp v58, v58, v58 row_ror:4 row_mask:0xf bank_mask:0xf
    v_add_f32_dpp v59, v59, v59 row_ror:4 row_mask:0xf bank_mask:0xf
    v_add_f32_dpp v56, v56, v56 row_ror:8 row_mask:0xf bank_mask:0xf
    v_add_f32_dpp v57, v57, v57 row_ror:8 row_mask:0xf bank_mask:0xf
    v_add_f32_dpp v58, v58, v58 row_ror:8 row_mask:0xf bank_mask:0xf
    v_add_f32_dpp v59, v59, v59 row_ror:8 row_mask:0xf bank_mask:0xf
    v_mov_b32 v60, v56
    v_mov_b32 v61, v57
    v_mov_b32 v62, v58
    v_mov_b32 v63, v59
    s_nop 0
    v_permlane16_swap_b32 v56, v60
    v_permlane16_swap_b32 v57, v61
    v_permlane16_swap_b32 v58, v62
    v_permlane16_swap_b32 v59, v63
    v_add_f32 v56, v56, v60
    v_add_f32 v57, v57, v61
    v_add_f32 v58, v58, v62
    v_add_f32 v59, v59, v63
    v_mov_b32 v60, v56
    v_mov_b32 v61, v57
    v_mov_b32 v62, v58
    v_mov_b32 v63, v59
    s_nop 0
    v_permlane32_swap_b32 v56, v60
    v_permlane32_swap_b32 v57, v61
    v_permlane32_swap_b32 v58, v62
    v_permlane32_swap_b32 v59, v63
    v_add_f32 v56, v56, v60
    v_add_f32 v57, v57, v61
    v_add_f32 v58, v58, v62
    v_add_f32 v59, v59, v63
    v_cvt_pk_bf16_f32 v56, v56, v56
    v_and_b32 v56, 0xffff0000, v56
    v_mul_f32 v37, 0xbfb8aa3b, v56
    v_exp_f32 v37, v37
    s_nop 0
    v_add_f32 v37, 1.0, v37
    v_rcp_f32 v37, v37
    s_nop 0
    v_mul_f32 v56, v56, v37
    v_cvt_pk_bf16_f32 v56, v56, v56
    v_and_b32 v56, 0xffff0000, v56
    v_cvt_pk_bf16_f32 v57, v57, v57
    v_and_b32 v57, 0xffff0000, v57
    v_mul_f32 v37, 0xbfb8aa3b, v57
    v_exp_f32 v37, v37
    s_nop 0
    v_add_f32 v37, 1.0, v37
    v_rcp_f32 v37, v37
    s_nop 0
    v_mul_f32 v57, v57, v37
    v_cvt_pk_bf16_f32 v57, v57, v57
    v_and_b32 v57, 0xffff0000, v57
    v_cvt_pk_bf16_f32 v58, v58, v58
    v_and_b32 v58, 0xffff0000, v58
    v_mul_f32 v37, 0xbfb8aa3b, v58
    v_exp_f32 v37, v37
    s_nop 0
    v_add_f32 v37, 1.0, v37
    v_rcp_f32 v37, v37
    s_nop 0
    v_mul_f32 v58, v58, v37
    v_cvt_pk_bf16_f32 v58, v58, v58
    v_and_b32 v58, 0xffff0000, v58
    v_cvt_pk_bf16_f32 v59, v59, v59
    v_and_b32 v59, 0xffff0000, v59
    v_mul_f32 v37, 0xbfb8aa3b, v59
    v_exp_f32 v37, v37
    s_nop 0
    v_add_f32 v37, 1.0, v37
    v_rcp_f32 v37, v37
    s_nop 0
    v_mul_f32 v59, v59, v37
    v_cvt_pk_bf16_f32 v59, v59, v59
    v_and_b32 v59, 0xffff0000, v59
    v_lshlrev_b32 v38, 16, v80
    v_and_b32 v39, 0xffff0000, v80
    v_lshlrev_b32 v40, 16, v81
    v_and_b32 v41, 0xffff0000, v81
    s_waitcnt vmcnt(0)
    v_perm_b32 v35, v65, v64, s92
    v_perm_b32 v35, v66, v35, s93
    v_perm_b32 v35, v67, v35, s94
    v_xor_b32 v35, s59, v35
    v_perm_b32 v36, v69, v68, s92
    v_perm_b32 v36, v70, v36, s93
    v_perm_b32 v36, v71, v36, s94
    v_xor_b32 v36, s59, v36
    v_or_b32 v35, v35, v36
    v_cmp_ne_u32 vcc, 0, v35
    s_cbranch_vccz Lok_s_48
    s_mov_b64 exec, vcc
    global_load_dwordx4 v[64:67], v48, s[56:57] offset:128 sc1
    s_mov_b32 exec_hi, 0
    global_load_dwordx4 v[68:71], v49, s[56:57] offset:128 sc1
    s_mov_b64 exec, -1
    s_sleep 2
Llp_s_49:
    s_add_u32 s44, s44, 1
    s_cmp_gt_u32 s44, 400000
    s_cbranch_scc1 Lok_s_48
    s_mov_b64 exec, vcc
    global_load_dwordx4 v[64:67], v48, s[56:57] offset:128 sc1
    s_mov_b32 exec_hi, 0
    global_load_dwordx4 v[68:71], v49, s[56:57] offset:128 sc1
    s_mov_b64 exec, -1
    s_waitcnt vmcnt(2)
    v_perm_b32 v35, v65, v64, s92
    v_perm_b32 v35, v66, v35, s93
    v_perm_b32 v35, v67, v35, s94
    v_xor_b32 v35, s59, v35
    v_perm_b32 v36, v69, v68, s92
    v_perm_b32 v36, v70, v36, s93
    v_perm_b32 v36, v71, v36, s94
    v_xor_b32 v36, s59, v36
    v_or_b32 v35, v35, v36
    v_cmp_ne_u32 vcc, 0, v35
    s_cbranch_vccnz Llp_s_49
Lok_s_48:
    v_and_b32 v72, 0xffffff00, v64
    v_and_b32 v73, 0xffffff00, v65
    v_and_b32 v74, 0xffffff00, v66
    v_and_b32 v75, 0xffffff00, v67
    v_and_b32 v76, 0xffffff00, v68
    v_and_b32 v77, 0xffffff00, v69
    v_and_b32 v78, 0xffffff00, v70
    v_and_b32 v79, 0xffffff00, v71
    v_pk_add_f32 v[72:73], v[72:73], v[76:77]
    v_pk_add_f32 v[74:75], v[74:75], v[78:79]
    s_nop 0
    v_add_f32_dpp v72, v72, v72 row_ror:4 row_mask:0xf bank_mask:0xf
    v_add_f32_dpp v73, v73, v73 row_ror:4 row_mask:0xf bank_mask:0xf
    v_add_f32_dpp v74, v74, v74 row_ror:4 row_mask:0xf bank_mask:0xf
    v_add_f32_dpp v75, v75, v75 row_ror:4 row_mask:0xf bank_mask:0xf
    v_add_f32_dpp v72, v72, v72 row_ror:8 row_mask:0xf bank_mask:0xf
    v_add_f32_dpp v73, v73, v73 row_ror:8 row_mask:0xf bank_mask:0xf
    v_add_f32_dpp v74, v74, v74 row_ror:8 row_mask:0xf bank_mask:0xf
    v_add_f32_dpp v75, v75, v75 row_ror:8 row_mask:0xf bank_mask:0xf
    v_mov_b32 v76, v72
    v_mov_b32 v77, v73
    v_mov_b32 v78, v74
    v_mov_b32 v79, v75
    s_nop 0
    v_permlane16_swap_b32 v72, v76
    v_permlane16_swap_b32 v73, v77
    v_permlane16_swap_b32 v74, v78
    v_permlane16_swap_b32 v75, v79
    v_add_f32 v72, v72, v76
    v_add_f32 v73, v73, v77
    v_add_f32 v74, v74, v78
    v_add_f32 v75, v75, v79
    v_mov_b32 v76, v72
    v_mov_b32 v77, v73
    v_mov_b32 v78, v74
    v_mov_b32 v79, v75
    s_nop 0
    v_permlane32_swap_b32 v72, v76
    v_permlane32_swap_b32 v73, v77
    v_permlane32_swap_b32 v74, v78
    v_permlane32_swap_b32 v75, v79
    v_add_f32 v72, v72, v76
    v_add_f32 v73, v73, v77
    v_add_f32 v74, v74, v78
    v_add_f32 v75, v75, v79
    v_cvt_pk_bf16_f32 v72, v72, v72
    v_and_b32 v72, 0xffff0000, v72
    v_mul_f32 v72, v72, v56
    v_cvt_pk_bf16_f32 v72, v72, v72
    v_and_b32 v72, 0xffff0000, v72
    v_add_f32 v72, v72, v38
    v_cvt_pk_bf16_f32 v73, v73, v73
    v_and_b32 v73, 0xffff0000, v73
    v_mul_f32 v73, v73, v57
    v_cvt_pk_bf16_f32 v73, v73, v73
    v_and_b32 v73, 0xffff0000, v73
    v_add_f32 v73, v73, v39
    v_cvt_pk_bf16_f32 v74, v74, v74
    v_and_b32 v74, 0xffff0000, v74
    v_mul_f32 v74, v74, v58
    v_cvt_pk_bf16_f32 v74, v74, v74
    v_and_b32 v74, 0xffff0000, v74
    v_add_f32 v74, v74, v40
    v_cvt_pk_bf16_f32 v75, v75, v75
    v_and_b32 v75, 0xffff0000, v75
    v_mul_f32 v75, v75, v59
    v_cvt_pk_bf16_f32 v75, v75, v75
    v_and_b32 v75, 0xffff0000, v75
    v_add_f32 v75, v75, v41
    v_cvt_pk_bf16_f32 v42, v72, v73
    v_cvt_pk_bf16_f32 v43, v74, v75
    s_mov_b64 exec, 0xf
    global_store_dwordx2 v34, v[42:43], s[22:23]
    s_cmp_eq_u32 s15, 240
    s_cbranch_scc0 Lskip_ep_50
    s_cmp_eq_u32 s3, 0
    s_cbranch_scc0 Lskip_ep_50
    s_mov_b64 exec, 1
    v_mov_b32 v44, 0xf0000
    v_mov_b32 v45, s58
    global_store_dword v44, v45, s[26:27]
Lskip_ep_50:
    s_mov_b64 exec, -1
Lskip_fin_45:
L_end:
    s_endpgm
L_codeend:
.section .rodata,"a"
.p2align 6
.amdhsa_kernel recurrent_scan__mha_block_cached__swiglu_ffn__decode_kernel
  .amdhsa_next_free_vgpr 256
  .amdhsa_next_free_sgpr 102
  .amdhsa_accum_offset 256
  .amdhsa_group_segment_fixed_size 0
  .amdhsa_kernarg_size 96
  .amdhsa_user_sgpr_count 2
  .amdhsa_user_sgpr_kernarg_segment_ptr 1
  .amdhsa_system_sgpr_workgroup_id_x 1
.end_amdhsa_kernel
```
